```python
import torch

def _softmax(x, axis=-1):
    return torch.softmax(x, dim=axis)
def _gelu(x):
    return torch.nn.functional.gelu(x, approximate="tanh")
def _silu(x):
    return torch.nn.functional.silu(x)
def _sigmoid(x):
    return torch.sigmoid(x)
def _layernorm(x, axis=-1, eps=1e-5):
    m = x.mean(dim=axis, keepdim=True)
    v = x.var(dim=axis, keepdim=True, unbiased=False)
    return (x - m) / torch.sqrt(v + eps)
def _scatter_add(tgt, idx, src, axis=0):
    return tgt.clone().index_add_(axis, idx, src)
def _segment_sum(src, seg, n):
    out = torch.zeros((n,) + src.shape[1:], dtype=src.dtype)
    return out.index_add_(0, seg, src)
def _pad(x, pw):
    flat = tuple(v for pair in reversed(pw) for v in pair)
    return torch.nn.functional.pad(x, flat)

kernel_name = 'gated_mix__linear_attn_block__glu_gated_swiglu__prompt'

def setup_inputs():

    _w = (lambda a: (lambda t: t.to(torch.bfloat16) if t.is_floating_point() else t)(torch.as_tensor(a)))
    def _A_setup():
        B, S, D = 1, 2048, 512
        return {
            "x": _w((lambda *s: torch.randn(*s, dtype=torch.bfloat16) * 0.05)(B, S, D)),
            "wqkv": _w((lambda *s: torch.randn(*s, dtype=torch.bfloat16) * 0.8)(D, 3 * D)),
            "wo": _w((lambda *s: torch.randn(*s, dtype=torch.bfloat16) * 0.05)(D, D)),
        }
    _A_in = _A_setup()

    def _B_setup():
        B, S, D, F = 1, 2048, 512, 1376
        return {
            "x": _w((lambda *s: torch.randn(*s, dtype=torch.bfloat16) * 0.05)(B, S, D)),
            "w1": _w((lambda *s: torch.randn(*s, dtype=torch.bfloat16) * 1.6)(D, F) * (2.0 / D) ** 0.5),
            "w3": _w((lambda *s: torch.randn(*s, dtype=torch.bfloat16) * 1.6)(D, F) * (2.0 / D) ** 0.5),
            "w2": _w((lambda *s: torch.randn(*s, dtype=torch.bfloat16) * 1.6)(F, D) * (2.0 / F) ** 0.5),
        }
    _B_in = _B_setup()

    return {
        "A_x": _A_in["x"],
        "A_wqkv": _A_in["wqkv"],
        "A_wo": _A_in["wo"],
        "B_x": _B_in["x"],
        "B_w1": _B_in["w1"],
        "B_w3": _B_in["w3"],
        "B_w2": _B_in["w2"],
        "gate_w": _w((lambda *s: torch.randn(*s, dtype=torch.bfloat16) * 0.05)(512) * 16.0),
    }

def reference(A_x, A_wqkv, A_wo, B_x, B_w1, B_w3, B_w2, gate_w):
    def _A_ref(x, wqkv, wo):
        B, S, D = x.shape
        H = 32; Dh = D // H
        qkv = (lambda x, *d: x.permute(*d))((x @ wqkv).reshape(B, S, 3, H, Dh), 2, 0, 3, 1, 4)
        q, k, v = qkv[0], qkv[1], qkv[2]
        phi = lambda t: torch.where(t > 0, t + 1, torch.exp(t)) + 1e-6
        pq, pk = phi(q), phi(k)
        kv = torch.einsum("bhsd,bhse->bhde", pk, v)
        z = torch.einsum("bhsd->bhd", pk)
        num = torch.einsum("bhqd,bhde->bhqe", pq, kv)
        den = torch.einsum("bhqd,bhd->bhq", pq, z)[..., None] + 1e-6
        o = num / den
        return (lambda x, *d: x.permute(*d))(o, 0, 2, 1, 3).reshape(B, S, D) @ wo

    def _B_ref(x, w1, w3, w2):
        gate = torch.einsum("bsd,df->bsf", x, w1)
        up = torch.einsum("bsd,df->bsf", x, w3)
        h = _silu(gate) * up
        out = torch.einsum("bsf,fd->bsd", h, w2)
        return out

    x = A_x
    g = _sigmoid((x * gate_w).sum(-1, keepdims=True))
    a = _A_ref(x, A_wqkv, A_wo)
    b = _B_ref(x, B_w1, B_w3, B_w2)
    return g * a + (1 - g) * b
```

```asm
; @launch grid=(256,1,1) block=(512,1,1) lds=163840
.amdgcn_target "amdgcn-amd-amdhsa--gfx950"
.text
.p2align 12
.globl gated_mix__linear_attn_block__glu_gated_swiglu__prompt_kernel
.p2align 8
.type gated_mix__linear_attn_block__glu_gated_swiglu__prompt_kernel,@function
gated_mix__linear_attn_block__glu_gated_swiglu__prompt_kernel:
s_cmp_ge_u32 s2, 256
s_cbranch_scc1 L_exit
v_lshrrev_b32 v1, 6, v0
s_load_dwordx16 s[4:19], s[0:1], 0
v_readfirstlane_b32 s28, v1
s_load_dwordx2 s[20:21], s[0:1], 64
s_load_dwordx2 s[24:25], s[0:1], 80
v_and_b32 v0, 63, v0
v_lshlrev_b32 v251, 4, v0
s_cmp_ge_u32 s28, 4
s_cbranch_scc1 L_start
s_getpc_b64 s[48:49]
M_pc:
s_and_b32 s49, s49, 0xffff
s_mov_b32 s50, L_codeend-M_pc
s_mov_b32 s51, 0x00020000
s_lshr_b32 s30, s2, 3
s_lshl_b32 s30, s30, 2
s_add_u32 s30, s30, s28
s_lshl_b32 s30, s30, 8
s_min_u32 s30, s30, L_codeend-M_pc-256
s_buffer_load_dword s3, s[48:51], s30 offset:0
s_buffer_load_dword s3, s[48:51], s30 offset:64
s_buffer_load_dword s3, s[48:51], s30 offset:128
s_buffer_load_dword s3, s[48:51], s30 offset:192
s_branch M_start
L_start:
s_setprio 3
s_and_b32 s30, s2, 1
s_lshr_b32 s31, s2, 3
s_bfe_u32 s52, s2, 0x20001
s_lshl_b32 s30, s30, 5
s_add_u32 s30, s30, s31
s_cmp_eq_u32 s52, 3
s_cselect_b32 s54, 52, 43
s_cselect_b32 s55, 5, 6
s_cselect_b32 s56, 55, 54
s_mul_i32 s26, s30, s54
s_lshr_b32 s26, s26, 8
s_mul_i32 s31, s26, s55
s_sub_u32 s27, s30, s31
s_sub_u32 s57, s30, s56
s_cmp_ge_u32 s57, 5
s_cselect_b32 s58, 10, 9
s_cselect_b32 s31, 5, 0
s_sub_u32 s59, s57, s31
s_and_b32 s60, s57, 1
s_add_u32 s60, s60, 9
s_lshr_b32 s61, s57, 1
s_cmp_eq_u32 s52, 3
s_cselect_b32 s58, s60, s58
s_cselect_b32 s59, 5, s59
s_cselect_b32 s61, s61, s52
s_cmp_lt_u32 s30, s56
s_cselect_b32 s26, s26, s58
s_cselect_b32 s27, s27, s59
s_cselect_b32 s52, s52, s61
s_lshl_b32 s52, s52, 1
s_add_u32 s31, s52, 6
s_cmp_lt_u32 s27, 2
s_cselect_b32 s31, 0, s31
s_add_u32 s27, s27, s52
s_add_u32 s27, s27, s31
s_min_u32 s27, s27, 23
s_sub_u32 s52, s28, 4
s_mul_i32 s29, s26, 192
v_lshrrev_b32 v2, 3, v0
v_and_b32 v3, 7, v0
v_lshrrev_b32 v4, 4, v0
s_mul_i32 s54, s52, 48
s_add_u32 s54, s54, s29
s_lshl_b32 s54, s54, 10
s_cmp_eq_u32 s27, 23
s_cselect_b32 s54, 0x40000000, s54
v_xor_b32 v5, v3, v4
v_lshl_add_u32 v5, v5, 4, s54
v_lshl_add_u32 v16, v2, 10, v5
v_xor_b32 v7, 64, v16
v_add_u32 v17, 8192, v7
v_add_u32 v18, 16384, v16
v_add_u32 v19, 24576, v7
v_add_u32 v20, 32768, v16
v_add_u32 v21, 40960, v7
s_mul_i32 s53, s52, 6144
s_and_b32 s65, s2, 1
s_lshl_b32 s65, s65, 2
s_and_b32 s75, 1, s26
s_mul_i32 s75, s75, 1
s_mov_b32 s74, s65
s_add_u32 s65, s65, s75
s_and_b32 s65, s65, 7
s_lshl_b32 s54, s65, 7
s_mov_b32 s34, 0x200000
s_mov_b32 s35, 0x00020000
s_mov_b32 s39, s35
s_mov_b32 s51, s35
s_movk_i32 s50, 0x400
s_lshl_b32 s66, s2, 13
s_lshl_b32 s31, s52, 11
s_add_u32 s66, s66, s31
s_waitcnt lgkmcnt(0)
s_mov_b32 s32, s4
s_and_b32 s33, s5, 0xffff
s_mov_b32 s48, s18
s_and_b32 s49, s19, 0xffff
s_add_u32 m0, s53, 0
s_nop 0
buffer_load_dwordx4 v16, s[32:35], s54 offen lds
s_add_u32 m0, s53, 1024
s_nop 0
buffer_load_dwordx4 v17, s[32:35], s54 offen lds
s_add_u32 m0, s53, 2048
s_nop 0
buffer_load_dwordx4 v18, s[32:35], s54 offen lds
s_add_u32 m0, s53, 3072
s_nop 0
buffer_load_dwordx4 v19, s[32:35], s54 offen lds
s_add_u32 m0, s53, 4096
s_nop 0
buffer_load_dwordx4 v20, s[32:35], s54 offen lds
s_and_b32 s67, s2, 6
s_cmp_eq_u32 s67, 2
s_cbranch_scc0 L_h31
s_and_b32 s67, 1, s2
s_lshl_b32 s67, s67, 5
s_lshr_b32 s31, s2, 3
s_add_u32 s67, s67, s31
s_lshl_b32 s67, s67, 2
s_add_u32 s67, s67, s52
s_mul_i32 s67, s67, 6144
s_load_dword s10, s[6:7], s67 offset:384
s_load_dword s10, s[6:7], s67 offset:448
s_load_dword s10, s[6:7], s67 offset:1408
s_load_dword s10, s[6:7], s67 offset:1472
s_load_dword s10, s[6:7], s67 offset:2432
s_load_dword s10, s[6:7], s67 offset:2496
s_load_dword s10, s[6:7], s67 offset:3456
s_load_dword s10, s[6:7], s67 offset:3520
s_load_dword s10, s[6:7], s67 offset:4480
s_load_dword s10, s[6:7], s67 offset:4544
s_load_dword s10, s[6:7], s67 offset:5504
s_load_dword s10, s[6:7], s67 offset:5568
L_h31:
s_add_u32 m0, s53, 5120
s_nop 0
buffer_load_dwordx4 v21, s[32:35], s54 offen lds
s_cmp_lt_u32 s27, 8
s_cbranch_scc1 L_qkv
s_cmp_eq_u32 s27, 22
s_cselect_b32 s31, 4, 12
s_cmp_eq_u32 s27, 23
s_cselect_b32 s31, 0, s31
v_bfrev_b32 v11, 2
v_add_u32 v8, 0, v0
v_mul_u32_u24 v9, 43691, v8
v_lshrrev_b32 v9, 19, v9
v_mul_u32_u24 v10, 12, v9
v_sub_u32 v10, v8, v10
v_cmp_gt_u32 vcc, s31, v10
v_lshrrev_b32 v8, 2, v9
v_and_b32 v8, 2, v8
v_xor_b32 v10, v10, v8
v_mul_u32_u24 v9, 2752, v9
v_lshl_add_u32 v9, v10, 4, v9
v_cndmask_b32 v22, v11, v9, vcc
v_add_u32 v25, 88064, v22
v_add_u32 v8, 64, v0
v_mul_u32_u24 v9, 43691, v8
v_lshrrev_b32 v9, 19, v9
v_mul_u32_u24 v10, 12, v9
v_sub_u32 v10, v8, v10
v_cmp_gt_u32 vcc, s31, v10
v_lshrrev_b32 v8, 2, v9
v_and_b32 v8, 2, v8
v_xor_b32 v10, v10, v8
v_mul_u32_u24 v9, 2752, v9
v_lshl_add_u32 v9, v10, 4, v9
v_cndmask_b32 v23, v11, v9, vcc
v_add_u32 v26, 88064, v23
v_add_u32 v8, 128, v0
v_mul_u32_u24 v9, 43691, v8
v_lshrrev_b32 v9, 19, v9
v_mul_u32_u24 v10, 12, v9
v_sub_u32 v10, v8, v10
v_cmp_gt_u32 vcc, s31, v10
v_lshrrev_b32 v8, 2, v9
v_and_b32 v8, 2, v8
v_xor_b32 v10, v10, v8
v_mul_u32_u24 v9, 2752, v9
v_lshl_add_u32 v9, v10, 4, v9
v_cndmask_b32 v24, v11, v9, vcc
v_add_u32 v27, 88064, v24
s_sub_u32 s3, s27, 8
s_mul_i32 s3, s3, 192
s_lshr_b32 s31, s52, 1
s_mul_i32 s67, s31, 44032
s_add_u32 s3, s3, s67
s_mov_b32 s56, 176128
s_mul_i32 s57, s31, 3072
s_and_b32 s31, s52, 1
s_mul_i32 s67, s31, 12288
s_add_u32 s57, s57, s67
s_add_u32 s57, s57, 24576
s_add_u32 s58, s57, 1024
s_add_u32 s59, s57, 2048
s_add_u32 s60, s57, 6144
s_add_u32 s61, s57, 7168
s_add_u32 s62, s57, 8192
s_mov_b32 s38, 1409024
s_mov_b32 s30, 1069066811
s_branch L_go
L_qkv:
v_and_b32 v8, 1, v4
v_lshlrev_b32 v8, 2, v8
v_xor_b32 v8, v8, v3
s_and_b32 s31, s52, 1
s_lshl_b32 s31, s31, 1
v_xor_b32 v8, s31, v8
v_mul_u32_u24 v9, 3072, v2
v_lshl_add_u32 v22, v8, 4, v9
v_add_u32 v23, 1024, v22
v_add_u32 v24, 2048, v22
v_add_u32 v25, 98304, v22
v_add_u32 v26, 99328, v22
v_add_u32 v27, 100352, v22
s_lshl_b32 s3, s27, 7
s_mul_i32 s67, s52, 24576
s_add_u32 s3, s3, s67
s_mov_b32 s56, 196608
s_lshl_b32 s67, s52, 10
s_add_u32 s57, s67, 24576
s_add_u32 s58, s57, 8192
s_add_u32 s59, s57, 16384
s_add_u32 s60, s57, 4096
s_add_u32 s61, s57, 12288
s_add_u32 s62, s57, 20480
s_mov_b32 s38, 1572864
s_mov_b32 s30, 3216550459
L_go:
s_mul_i32 s55, s65, s56
s_add_u32 s55, s55, s3
s_bitcmp1_b32 s52, 0
s_cselect_b32 s36, s14, s12
s_cselect_b32 s37, s15, s13
s_cmp_lt_u32 s27, 8
s_cselect_b32 s36, s6, s36
s_cselect_b32 s37, s7, s37
s_and_b32 s37, s37, 0xffff
s_mov_b32 s67, 11534336
s_load_dwordx2 s[22:23], s[24:25], s67
s_lshl_b32 s67, s2, 6
s_add_u32 s67, s67, 11010048
s_load_dword s10, s[24:25], s67
s_add_u32 m0, s57, 0
s_nop 0
buffer_load_dwordx4 v22, s[36:39], s55 offen lds
s_add_u32 m0, s58, 0
s_nop 0
buffer_load_dwordx4 v23, s[36:39], s55 offen lds
s_add_u32 m0, s59, 0
s_nop 0
buffer_load_dwordx4 v24, s[36:39], s55 offen lds
s_add_u32 m0, s60, 0
s_nop 0
buffer_load_dwordx4 v25, s[36:39], s55 offen lds
s_add_u32 m0, s61, 0
s_nop 0
buffer_load_dwordx4 v26, s[36:39], s55 offen lds
s_add_u32 m0, s62, 0
s_nop 0
buffer_load_dwordx4 v27, s[36:39], s55 offen lds
buffer_load_dwordx4 v[124:127], v251, s[32:35], s66 offen
buffer_load_dwordx4 v[128:131], v251, s[32:35], s66 offen offset:1024
buffer_load_dwordx4 v[120:123], v251, s[48:51], 0 offen
s_mov_b32 s11, s74
s_mov_b32 s19, s75
s_mov_b32 s44, s24
s_and_b32 s45, s25, 0xffff
s_mov_b32 s46, 16777216
s_mov_b32 s47, 0x00020000
s_mov_b32 s72, s8
s_and_b32 s73, s9, 0xffff
s_mov_b32 s74, 524288
s_mov_b32 s75, 0x00020000
s_mov_b32 s68, s16
s_and_b32 s69, s17, 0xffff
s_mov_b32 s70, 1409024
s_mov_b32 s71, 0x00020000
s_xor_b32 s54, s19, 1
s_add_u32 s54, s54, s11
s_and_b32 s54, s54, 7
s_mul_i32 s55, s54, s56
s_add_u32 s55, s55, s3
s_lshl_b32 s54, s54, 7
s_add_u32 m0, s53, 49152
s_nop 0
buffer_load_dwordx4 v16, s[32:35], s54 offen lds
s_waitcnt vmcnt(7)
s_barrier
s_add_u32 m0, s57, 49152
s_nop 0
buffer_load_dwordx4 v22, s[36:39], s55 offen lds
s_add_u32 m0, s53, 50176
s_nop 0
buffer_load_dwordx4 v17, s[32:35], s54 offen lds
s_add_u32 m0, s58, 49152
s_nop 0
buffer_load_dwordx4 v23, s[36:39], s55 offen lds
s_add_u32 m0, s53, 51200
s_nop 0
buffer_load_dwordx4 v18, s[32:35], s54 offen lds
s_add_u32 m0, s59, 49152
s_nop 0
buffer_load_dwordx4 v24, s[36:39], s55 offen lds
s_add_u32 m0, s53, 52224
s_nop 0
buffer_load_dwordx4 v19, s[32:35], s54 offen lds
s_add_u32 m0, s60, 49152
s_nop 0
buffer_load_dwordx4 v25, s[36:39], s55 offen lds
s_waitcnt lgkmcnt(0)
s_add_u32 s22, s22, 0x7f4a7c15
s_addc_u32 s23, s23, 0x9e3779b9
s_waitcnt vmcnt(8)
v_mov_b32 v8, 0
v_mov_b32 v9, 0
v_dot2c_f32_bf16 v8, v124, v120
v_dot2c_f32_bf16 v9, v128, v120
v_dot2c_f32_bf16 v8, v125, v121
v_dot2c_f32_bf16 v9, v129, v121
v_dot2c_f32_bf16 v8, v126, v122
v_dot2c_f32_bf16 v9, v130, v122
v_dot2c_f32_bf16 v8, v127, v123
v_dot2c_f32_bf16 v9, v131, v123
s_lshr_b32 s66, s66, 7
s_add_u32 s66, s66, 11009040
s_nop 0
v_add_f32_dpp v8, v8, v8 quad_perm:[1,0,3,2] row_mask:0xf bank_mask:0xf
v_add_f32_dpp v9, v9, v9 quad_perm:[1,0,3,2] row_mask:0xf bank_mask:0xf
s_nop 0
v_add_f32_dpp v8, v8, v8 quad_perm:[2,3,0,1] row_mask:0xf bank_mask:0xf
v_add_f32_dpp v9, v9, v9 quad_perm:[2,3,0,1] row_mask:0xf bank_mask:0xf
s_nop 0
v_add_f32_dpp v8, v8, v8 row_half_mirror row_mask:0xf bank_mask:0xf
v_add_f32_dpp v9, v9, v9 row_half_mirror row_mask:0xf bank_mask:0xf
s_nop 0
v_add_f32_dpp v8, v8, v8 row_mirror row_mask:0xf bank_mask:0xf
v_add_f32_dpp v9, v9, v9 row_mirror row_mask:0xf bank_mask:0xf
s_nop 0
v_add_f32_dpp v8, v8, v8 row_bcast:15 row_mask:0xa bank_mask:0xf
v_add_f32_dpp v9, v9, v9 row_bcast:15 row_mask:0xa bank_mask:0xf
s_nop 0
v_add_f32_dpp v8, v8, v8 row_bcast:31 row_mask:0xc bank_mask:0xf
v_add_f32_dpp v9, v9, v9 row_bcast:31 row_mask:0xc bank_mask:0xf
s_nop 0
v_mov_b32 v10, s22
v_mov_b32 v11, s23
s_setprio 0
s_waitcnt vmcnt(11)
s_barrier
s_add_u32 m0, s53, 53248
s_nop 0
buffer_load_dwordx4 v20, s[32:35], s54 offen lds
s_add_u32 m0, s61, 49152
s_nop 0
buffer_load_dwordx4 v26, s[36:39], s55 offen lds
s_add_u32 m0, s53, 54272
s_nop 0
buffer_load_dwordx4 v21, s[32:35], s54 offen lds
s_add_u32 m0, s62, 49152
s_nop 0
buffer_load_dwordx4 v27, s[36:39], s55 offen lds
s_brev_b64 exec, 1
buffer_store_dwordx4 v[8:11], v251, s[44:47], s66 offen sc1
s_mov_b64 exec, -1
s_mov_b32 s54, 2
s_add_u32 s54, s54, s11
s_and_b32 s54, s54, 7
s_mul_i32 s55, s54, s56
s_add_u32 s55, s55, s3
s_lshl_b32 s54, s54, 7
s_add_u32 m0, s57, 98304
s_nop 0
buffer_load_dwordx4 v22, s[36:39], s55 offen lds
s_add_u32 m0, s58, 98304
s_nop 0
buffer_load_dwordx4 v23, s[36:39], s55 offen lds
s_add_u32 m0, s59, 98304
s_nop 0
buffer_load_dwordx4 v24, s[36:39], s55 offen lds
s_add_u32 m0, s60, 98304
s_nop 0
buffer_load_dwordx4 v25, s[36:39], s55 offen lds
s_add_u32 m0, s61, 98304
s_nop 0
buffer_load_dwordx4 v26, s[36:39], s55 offen lds
s_add_u32 m0, s62, 98304
s_nop 0
buffer_load_dwordx4 v27, s[36:39], s55 offen lds
s_waitcnt vmcnt(7)
s_barrier
s_add_u32 m0, s53, 98304
s_nop 0
buffer_load_dwordx4 v16, s[32:35], s54 offen lds
s_add_u32 m0, s53, 99328
s_nop 0
buffer_load_dwordx4 v17, s[32:35], s54 offen lds
s_add_u32 m0, s53, 100352
s_nop 0
buffer_load_dwordx4 v18, s[32:35], s54 offen lds
s_add_u32 m0, s53, 101376
s_nop 0
buffer_load_dwordx4 v19, s[32:35], s54 offen lds
s_add_u32 m0, s53, 102400
s_nop 0
buffer_load_dwordx4 v20, s[32:35], s54 offen lds
s_add_u32 m0, s53, 103424
s_nop 0
buffer_load_dwordx4 v21, s[32:35], s54 offen lds
s_add_u32 s54, s54, 128
s_add_u32 s55, s55, s56
s_and_b32 s54, s54, 0x3ff
s_cselect_b32 s55, s55, s3
s_add_u32 m0, s57, 0
s_nop 0
buffer_load_dwordx4 v22, s[36:39], s55 offen lds
s_add_u32 m0, s58, 0
s_nop 0
buffer_load_dwordx4 v23, s[36:39], s55 offen lds
s_add_u32 m0, s59, 0
s_nop 0
buffer_load_dwordx4 v24, s[36:39], s55 offen lds
s_add_u32 m0, s60, 0
s_nop 0
buffer_load_dwordx4 v25, s[36:39], s55 offen lds
s_add_u32 m0, s61, 0
s_nop 0
buffer_load_dwordx4 v26, s[36:39], s55 offen lds
s_add_u32 m0, s62, 0
s_nop 0
buffer_load_dwordx4 v27, s[36:39], s55 offen lds
s_waitcnt vmcnt(6)
s_barrier
s_add_u32 m0, s53, 0
s_nop 0
buffer_load_dwordx4 v16, s[32:35], s54 offen lds
s_add_u32 m0, s53, 1024
s_nop 0
buffer_load_dwordx4 v17, s[32:35], s54 offen lds
s_add_u32 m0, s53, 2048
s_nop 0
buffer_load_dwordx4 v18, s[32:35], s54 offen lds
s_add_u32 m0, s53, 3072
s_nop 0
buffer_load_dwordx4 v19, s[32:35], s54 offen lds
s_add_u32 m0, s53, 4096
s_nop 0
buffer_load_dwordx4 v20, s[32:35], s54 offen lds
s_add_u32 m0, s53, 5120
s_nop 0
buffer_load_dwordx4 v21, s[32:35], s54 offen lds
s_bfe_u32 s31, s2, 0x30003
s_lshl_b32 s31, s31, 7
s_and_b32 s77, s52, 1
s_lshl_b32 s76, s77, 1
v_and_b32 v13, 1, v4
v_lshlrev_b32 v13, 2, v13
v_xor_b32 v13, v13, v3
v_xor_b32 v13, s76, v13
v_lshlrev_b32 v13, 4, v13
v_lshl_add_u32 v28, v2, 10, v13
s_lshl_b32 s67, s52, 13
s_add_u32 s64, s31, s67
s_lshr_b32 s67, s52, 1
s_lshl_b32 s67, s67, 15
s_add_u32 s78, s64, s67
s_lshl_b32 s63, s52, 10
v_add_u32 v29, s63, v251
v_add_u32 v30, 0x10000, v29
v_add_u32 v15, 0x20000, v29
s_and_b32 s31, s2, 7
s_lshl_b32 s31, s31, 2
s_lshr_b32 s67, s2, 6
s_add_u32 s31, s31, s67
s_lshl_b32 s31, s31, 1
s_add_u32 s31, s31, s77
s_mul_i32 s67, s31, 86
s_lshr_b32 s67, s67, 8
s_lshl_b32 s79, s67, 11
s_add_u32 s79, s79, 10485760
s_lshr_b32 s67, s67, 1
s_lshl_b32 s18, s67, 11
s_add_u32 s18, s18, 10530816
s_sub_u32 s79, s18, 45056
s_lshl_b32 s67, s2, 2
s_add_u32 s67, s67, s52
s_lshl_b32 s67, s67, 9
s_buffer_load_dword s10, s[72:75], s67 offset:0
s_buffer_load_dword s10, s[72:75], s67 offset:64
s_buffer_load_dword s10, s[72:75], s67 offset:128
s_buffer_load_dword s10, s[72:75], s67 offset:192
s_buffer_load_dword s10, s[72:75], s67 offset:256
s_buffer_load_dword s10, s[72:75], s67 offset:320
s_buffer_load_dword s10, s[72:75], s67 offset:384
s_buffer_load_dword s10, s[72:75], s67 offset:448
s_add_u32 s54, s54, 128
s_add_u32 s55, s55, s56
s_and_b32 s54, s54, 0x3ff
s_cselect_b32 s55, s55, s3
s_add_u32 m0, s53, 49152
s_nop 0
buffer_load_dwordx4 v16, s[32:35], s54 offen lds
s_add_u32 m0, s57, 49152
s_nop 0
buffer_load_dwordx4 v22, s[36:39], s55 offen lds
s_add_u32 m0, s53, 50176
s_nop 0
buffer_load_dwordx4 v17, s[32:35], s54 offen lds
s_add_u32 m0, s58, 49152
s_nop 0
buffer_load_dwordx4 v23, s[36:39], s55 offen lds
s_add_u32 m0, s53, 51200
s_nop 0
buffer_load_dwordx4 v18, s[32:35], s54 offen lds
s_add_u32 m0, s59, 49152
s_nop 0
buffer_load_dwordx4 v24, s[36:39], s55 offen lds
s_waitcnt vmcnt(6)
s_barrier
s_add_u32 m0, s53, 52224
s_nop 0
buffer_load_dwordx4 v19, s[32:35], s54 offen lds
s_add_u32 m0, s60, 49152
s_nop 0
buffer_load_dwordx4 v25, s[36:39], s55 offen lds
s_add_u32 m0, s53, 53248
s_nop 0
buffer_load_dwordx4 v20, s[32:35], s54 offen lds
s_add_u32 m0, s61, 49152
s_nop 0
buffer_load_dwordx4 v26, s[36:39], s55 offen lds
s_add_u32 m0, s53, 54272
s_nop 0
buffer_load_dwordx4 v21, s[32:35], s54 offen lds
s_add_u32 m0, s62, 49152
s_nop 0
buffer_load_dwordx4 v27, s[36:39], s55 offen lds
s_mul_i32 s67, s2, 5504
s_mul_i32 s31, s52, 704
s_add_u32 s67, s67, s31
s_add_u32 s67, s67, 0
s_min_u32 s67, s67, 1408320
s_buffer_load_dword s10, s[68:71], s67 offset:0
s_buffer_load_dword s10, s[68:71], s67 offset:64
s_buffer_load_dword s10, s[68:71], s67 offset:128
s_buffer_load_dword s10, s[68:71], s67 offset:192
s_buffer_load_dword s10, s[68:71], s67 offset:256
s_buffer_load_dword s10, s[68:71], s67 offset:320
s_buffer_load_dword s10, s[68:71], s67 offset:384
s_buffer_load_dword s10, s[68:71], s67 offset:448
s_buffer_load_dword s10, s[68:71], s67 offset:512
s_buffer_load_dword s10, s[68:71], s67 offset:576
s_buffer_load_dword s10, s[68:71], s67 offset:640
s_add_u32 s54, s54, 128
s_add_u32 s55, s55, s56
s_and_b32 s54, s54, 0x3ff
s_cselect_b32 s55, s55, s3
s_add_u32 m0, s53, 98304
s_nop 0
buffer_load_dwordx4 v16, s[32:35], s54 offen lds
s_add_u32 m0, s57, 98304
s_nop 0
buffer_load_dwordx4 v22, s[36:39], s55 offen lds
s_add_u32 m0, s53, 99328
s_nop 0
WS_0:
s_cbranch_execz WS_4
buffer_load_dwordx4 v17, s[32:35], s54 offen lds
s_add_u32 m0, s58, 98304
s_nop 0
buffer_load_dwordx4 v23, s[36:39], s55 offen lds
s_add_u32 m0, s53, 100352
s_nop 0
buffer_load_dwordx4 v18, s[32:35], s54 offen lds
s_add_u32 m0, s59, 98304
s_nop 0
buffer_load_dwordx4 v24, s[36:39], s55 offen lds
s_add_u32 m0, s53, 101376
s_nop 0
buffer_load_dwordx4 v19, s[32:35], s54 offen lds
s_add_u32 m0, s60, 98304
s_nop 0
buffer_load_dwordx4 v25, s[36:39], s55 offen lds
s_waitcnt vmcnt(8)
s_barrier
s_add_u32 m0, s53, 102400
s_nop 0
buffer_load_dwordx4 v20, s[32:35], s54 offen lds
s_add_u32 m0, s61, 98304
s_nop 0
buffer_load_dwordx4 v26, s[36:39], s55 offen lds
s_add_u32 m0, s53, 103424
s_nop 0
buffer_load_dwordx4 v21, s[32:35], s54 offen lds
s_add_u32 m0, s62, 98304
s_nop 0
buffer_load_dwordx4 v27, s[36:39], s55 offen lds
s_mul_i32 s67, s2, 5504
s_mul_i32 s31, s52, 704
s_add_u32 s67, s67, s31
s_add_u32 s67, s67, 2816
s_min_u32 s67, s67, 1408320
s_buffer_load_dword s10, s[68:71], s67 offset:0
s_buffer_load_dword s10, s[68:71], s67 offset:64
s_buffer_load_dword s10, s[68:71], s67 offset:128
s_buffer_load_dword s10, s[68:71], s67 offset:192
s_buffer_load_dword s10, s[68:71], s67 offset:256
s_buffer_load_dword s10, s[68:71], s67 offset:320
s_buffer_load_dword s10, s[68:71], s67 offset:384
s_buffer_load_dword s10, s[68:71], s67 offset:448
s_buffer_load_dword s10, s[68:71], s67 offset:512
s_buffer_load_dword s10, s[68:71], s67 offset:576
s_buffer_load_dword s10, s[68:71], s67 offset:640
s_add_u32 s54, s54, 128
s_add_u32 s55, s55, s56
s_and_b32 s54, s54, 0x3ff
s_cselect_b32 s55, s55, s3
s_add_u32 m0, s53, 0
s_nop 0
buffer_load_dwordx4 v16, s[32:35], s54 offen lds
s_add_u32 m0, s57, 0
s_nop 0
buffer_load_dwordx4 v22, s[36:39], s55 offen lds
s_add_u32 m0, s53, 1024
s_nop 0
buffer_load_dwordx4 v17, s[32:35], s54 offen lds
s_add_u32 m0, s58, 0
s_nop 0
buffer_load_dwordx4 v23, s[36:39], s55 offen lds
s_add_u32 m0, s53, 2048
s_nop 0
buffer_load_dwordx4 v18, s[32:35], s54 offen lds
s_add_u32 m0, s59, 0
s_nop 0
buffer_load_dwordx4 v24, s[36:39], s55 offen lds
s_add_u32 m0, s53, 3072
s_nop 0
buffer_load_dwordx4 v19, s[32:35], s54 offen lds
s_add_u32 m0, s60, 0
s_nop 0
buffer_load_dwordx4 v25, s[36:39], s55 offen lds
s_waitcnt vmcnt(8)
s_barrier
s_add_u32 m0, s53, 4096
s_nop 0
buffer_load_dwordx4 v20, s[32:35], s54 offen lds
s_add_u32 m0, s61, 0
s_nop 0
buffer_load_dwordx4 v26, s[36:39], s55 offen lds
s_add_u32 m0, s53, 5120
s_nop 0
buffer_load_dwordx4 v21, s[32:35], s54 offen lds
s_add_u32 m0, s62, 0
s_nop 0
buffer_load_dwordx4 v27, s[36:39], s55 offen lds
s_cmp_lt_u32 s27, 8
s_cbranch_scc1 L_spq
s_lshl_b32 s67, s26, 5
s_add_u32 s67, s67, s27
s_lshl_b32 s67, s67, 6
s_add_u32 s67, s67, 10485248
s_buffer_load_dword s10, s[44:47], s67
s_buffer_load_dword s10, s[44:47], s67 offset:64
s_branch L_spd
L_spq:
s_lshl_b32 s31, s27, 2
s_add_u32 s31, s31, s52
s_lshl_b32 s67, s26, 5
s_add_u32 s67, s67, s31
s_lshl_b32 s67, s67, 6
s_add_u32 s67, s67, 10530816
s_buffer_load_dword s10, s[44:47], s67
s_buffer_load_dword s10, s[44:47], s67 offset:64
s_mul_i32 s67, s31, 11
s_add_u32 s67, s67, s26
s_mul_i32 s67, s67, 1152
s_add_u32 s67, s67, 9437184
s_buffer_load_dword s10, s[44:47], s67 offset:0
s_buffer_load_dword s10, s[44:47], s67 offset:128
s_buffer_load_dword s10, s[44:47], s67 offset:256
s_buffer_load_dword s10, s[44:47], s67 offset:384
s_buffer_load_dword s10, s[44:47], s67 offset:512
s_buffer_load_dword s10, s[44:47], s67 offset:640
s_buffer_load_dword s10, s[44:47], s67 offset:768
s_buffer_load_dword s10, s[44:47], s67 offset:896
s_buffer_load_dword s10, s[44:47], s67 offset:1024
s_buffer_load_dword s10, s[44:47], s67 offset:1088
L_spd:
s_bitcmp0_b32 s52, 1
s_cbranch_scc0 L_c32
v_lshlrev_b32 v12, 10, v0
s_lshr_b32 s67, s2, 3
s_bitcmp0_b32 s52, 0
s_cbranch_scc0 L_c3b2
s_mul_i32 s67, s67, 44032
s_movk_i32 exec_hi, 0x7ff
buffer_load_dword v14, v12, s[68:71], s67 offen offset:384
s_branch L_c3c2
L_c3b2:
s_lshl_b32 s67, s67, 14
s_mov_b64 exec, 0xffff
buffer_load_dword v14, v12, s[72:75], s67 offen offset:384
L_c3c2:
s_mov_b64 exec, -1
L_c32:
s_mul_i32 s66, s52, 24
s_lshr_b32 s67, s29, 1
s_add_u32 s66, s66, s67
v_min_u32 v13, 23, v0
v_lshlrev_b32 v12, 3, v13
v_add_u32 v13, s66, v13
v_min_u32 v13, 0x3ff, v13
v_lshlrev_b32 v13, 4, v13
s_mul_i32 s67, s52, 192
s_add_u32 s67, s67, 159744
v_add_u32 v12, s67, v12
s_mov_b32 s66, 11010048
buffer_load_dwordx4 v[8:11], v13, s[44:47], s66 offen sc1
s_add_u32 s54, s54, 128
s_add_u32 s55, s55, s56
s_and_b32 s54, s54, 0x3ff
s_cselect_b32 s55, s55, s3
s_add_u32 m0, s53, 49152
s_nop 0
buffer_load_dwordx4 v16, s[32:35], s54 offen lds
s_add_u32 m0, s57, 49152
s_nop 0
buffer_load_dwordx4 v22, s[36:39], s55 offen lds
s_add_u32 m0, s53, 50176
s_nop 0
buffer_load_dwordx4 v17, s[32:35], s54 offen lds
s_add_u32 m0, s58, 49152
s_nop 0
buffer_load_dwordx4 v23, s[36:39], s55 offen lds
s_add_u32 m0, s53, 51200
s_nop 0
buffer_load_dwordx4 v18, s[32:35], s54 offen lds
s_add_u32 m0, s59, 49152
s_nop 0
buffer_load_dwordx4 v24, s[36:39], s55 offen lds
s_add_u32 m0, s53, 52224
s_nop 0
buffer_load_dwordx4 v19, s[32:35], s54 offen lds
s_add_u32 m0, s60, 49152
s_nop 0
buffer_load_dwordx4 v25, s[36:39], s55 offen lds
s_waitcnt vmcnt(8)
s_barrier
s_add_u32 m0, s53, 53248
s_nop 0
buffer_load_dwordx4 v20, s[32:35], s54 offen lds
s_add_u32 m0, s61, 49152
s_nop 0
buffer_load_dwordx4 v26, s[36:39], s55 offen lds
s_add_u32 m0, s53, 54272
s_nop 0
buffer_load_dwordx4 v21, s[32:35], s54 offen lds
s_add_u32 m0, s62, 49152
s_nop 0
buffer_load_dwordx4 v27, s[36:39], s55 offen lds
s_add_u32 s67, s64, 0
buffer_load_dwordx4 v[32:35], v28, s[72:75], s67 offen
s_add_u32 s67, s64, 262144
buffer_load_dwordx4 v[36:39], v28, s[72:75], s67 offen
s_add_u32 s67, s64, 32768
buffer_load_dwordx4 v[40:43], v28, s[72:75], s67 offen
s_add_u32 s67, s64, 294912
buffer_load_dwordx4 v[44:47], v28, s[72:75], s67 offen
s_mov_b32 s31, 0
L_gw:
v_cmp_eq_u64 vcc, s[22:23], v[10:11]
s_add_u32 s31, s31, 1
s_nop 0
s_cmp_eq_u64 vcc, -1
s_cbranch_scc1 L_gd
buffer_load_dwordx4 v[8:11], v13, s[44:47], s66 offen sc1
s_cmp_lt_u32 s31, 524288
s_waitcnt vmcnt(0)
s_cbranch_scc1 L_gw
L_gd:
v_mul_f32 v8, s30, v8
v_mul_f32 v9, s30, v9
v_exp_f32 v8, v8
v_exp_f32 v9, v9
s_mov_b32 s67, 0x7f000000
v_add_f32 v8, 1.0, v8
v_add_f32 v9, 1.0, v9
v_min_f32 v8, s67, v8
v_min_f32 v9, s67, v9
ds_write_b64 v12, v[8:9]
s_add_u32 s67, s64, 65536
buffer_load_dwordx4 v[48:51], v28, s[72:75], s67 offen
s_add_u32 s67, s64, 327680
buffer_load_dwordx4 v[52:55], v28, s[72:75], s67 offen
s_add_u32 s67, s64, 98304
buffer_load_dwordx4 v[56:59], v28, s[72:75], s67 offen
s_add_u32 s67, s64, 360448
buffer_load_dwordx4 v[60:63], v28, s[72:75], s67 offen
s_add_u32 s67, s64, 131072
buffer_load_dwordx4 v[64:67], v28, s[72:75], s67 offen
s_add_u32 s67, s64, 393216
buffer_load_dwordx4 v[68:71], v28, s[72:75], s67 offen
v_min_u32 v12, 14, v0
v_lshlrev_b32 v12, 6, v12
v_and_b32 v13, 31, v0
v_lshlrev_b32 v13, 6, v13
v_mov_b32 v14, 160512
s_waitcnt vmcnt(10) lgkmcnt(0)
s_barrier
s_add_u32 s67, s64, 163840
s_waitcnt vmcnt(8)
buffer_load_dwordx4 v[72:75], v28, s[72:75], s67 offen
s_add_u32 s67, s64, 425984
s_waitcnt vmcnt(8)
buffer_load_dwordx4 v[76:79], v28, s[72:75], s67 offen
s_add_u32 s67, s64, 196608
s_waitcnt vmcnt(8)
buffer_load_dwordx4 v[80:83], v28, s[72:75], s67 offen
s_add_u32 s67, s64, 458752
s_waitcnt vmcnt(8)
buffer_load_dwordx4 v[84:87], v28, s[72:75], s67 offen
s_add_u32 s67, s64, 229376
s_waitcnt vmcnt(8)
buffer_load_dwordx4 v[88:91], v28, s[72:75], s67 offen
s_add_u32 s67, s64, 491520
s_waitcnt vmcnt(8)
buffer_load_dwordx4 v[92:95], v28, s[72:75], s67 offen
s_add_u32 s67, s64, 622592
s_waitcnt vmcnt(8)
buffer_load_dwordx4 v[96:99], v28, s[68:71], s67 offen
s_add_u32 s67, s64, 1310720
s_waitcnt vmcnt(8)
buffer_load_dwordx4 v[100:103], v28, s[68:71], s67 offen
s_add_u32 s67, s64, 655360
s_waitcnt vmcnt(8)
buffer_load_dwordx4 v[104:107], v28, s[68:71], s67 offen
s_add_u32 s67, s64, 1343488
s_waitcnt vmcnt(8)
buffer_load_dwordx4 v[108:111], v28, s[68:71], s67 offen
s_add_u32 m0, s63, 98304
s_add_u32 s67, s64, 0
s_waitcnt vmcnt(8)
buffer_load_dwordx4 v28, s[68:71], s67 offen lds
s_add_u32 m0, s63, 102400
s_add_u32 s67, s64, 688128
s_waitcnt vmcnt(8)
buffer_load_dwordx4 v28, s[68:71], s67 offen lds
s_add_u32 m0, s63, 106496
s_add_u32 s67, s64, 32768
s_waitcnt vmcnt(8)
buffer_load_dwordx4 v28, s[68:71], s67 offen lds
s_add_u32 m0, s63, 110592
s_add_u32 s67, s64, 720896
s_waitcnt vmcnt(8)
buffer_load_dwordx4 v28, s[68:71], s67 offen lds
s_add_u32 m0, s63, 114688
s_add_u32 s67, s64, 65536
s_waitcnt vmcnt(8)
buffer_load_dwordx4 v28, s[68:71], s67 offen lds
s_add_u32 m0, s63, 118784
s_add_u32 s67, s64, 753664
s_waitcnt vmcnt(8)
buffer_load_dwordx4 v28, s[68:71], s67 offen lds
s_add_u32 m0, s63, 122880
s_add_u32 s67, s64, 98304
s_waitcnt vmcnt(8)
buffer_load_dwordx4 v28, s[68:71], s67 offen lds
s_add_u32 m0, s63, 126976
s_add_u32 s67, s64, 786432
s_waitcnt vmcnt(8)
buffer_load_dwordx4 v28, s[68:71], s67 offen lds
s_add_u32 m0, s63, 131072
s_add_u32 s67, s64, 131072
s_waitcnt vmcnt(8)
buffer_load_dwordx4 v28, s[68:71], s67 offen lds
s_add_u32 m0, s63, 135168
s_add_u32 s67, s64, 819200
s_waitcnt vmcnt(8)
buffer_load_dwordx4 v28, s[68:71], s67 offen lds
s_add_u32 m0, s63, 139264
s_add_u32 s67, s64, 163840
s_waitcnt vmcnt(8)
buffer_load_dwordx4 v28, s[68:71], s67 offen lds
s_add_u32 m0, s63, 143360
s_add_u32 s67, s64, 851968
s_waitcnt vmcnt(8)
buffer_load_dwordx4 v28, s[68:71], s67 offen lds
s_add_u32 m0, s63, 147456
s_add_u32 s67, s64, 196608
s_waitcnt vmcnt(8)
buffer_load_dwordx4 v28, s[68:71], s67 offen lds
s_add_u32 m0, s63, 151552
s_add_u32 s67, s64, 884736
s_waitcnt vmcnt(8)
buffer_load_dwordx4 v28, s[68:71], s67 offen lds
WS_1:
s_cbranch_execz WS_5
s_add_u32 m0, s63, 155648
s_add_u32 s67, s64, 1376256
s_waitcnt vmcnt(8)
buffer_load_dwordx4 v28, s[68:71], s67 offen lds
s_add_u32 m0, s63, 0
s_add_u32 s67, s64, 229376
s_waitcnt vmcnt(8)
buffer_load_dwordx4 v28, s[68:71], s67 offen lds
s_mov_b32 s48, s20
s_and_b32 s49, s21, 0xffff
s_mov_b32 s50, 2097152
s_mov_b32 s51, 0x00020000
v_lshrrev_b32 v8, 3, v0
s_lshl_b32 s42, s28, 3
v_add_u32 v8, s42, v8
v_and_b32 v9, 7, v0
v_and_b32 v254, 7, v8
v_xor_b32 v254, v254, v9
v_bfe_u32 v255, v8, 1, 1
v_lshl_or_b32 v254, v255, 3, v254
v_lshlrev_b32 v254, 4, v254
v_lshl_add_u32 v254, v8, 8, v254
v_lshlrev_b32 v8, 10, v8
v_lshl_add_u32 v255, v9, 4, v8
s_and_b32 s42, s2, 7
s_lshl_b32 s42, s42, 2
s_lshr_b32 s43, s2, 6
s_add_u32 s42, s42, s43
s_bfe_u32 s43, s2, 0x30003
s_lshl_b32 s43, s43, 7
s_lshl_b32 s42, s42, 16
s_add_u32 s42, s42, s43
s_cmp_lt_u32 s27, 8
s_cbranch_scc0 L_qx0
s_add_u32 m0, s63, 4096
s_add_u32 s67, s64, 917504
s_waitcnt vmcnt(8)
buffer_load_dwordx4 v28, s[68:71], s67 offen lds
s_add_u32 m0, s63, 8192
s_add_u32 s67, s64, 262144
s_waitcnt vmcnt(8)
buffer_load_dwordx4 v28, s[68:71], s67 offen lds
s_add_u32 m0, s63, 12288
s_add_u32 s67, s64, 950272
s_waitcnt vmcnt(8)
buffer_load_dwordx4 v28, s[68:71], s67 offen lds
s_add_u32 m0, s63, 16384
s_add_u32 s67, s64, 294912
s_waitcnt vmcnt(8)
buffer_load_dwordx4 v28, s[68:71], s67 offen lds
s_add_u32 m0, s63, 20480
s_add_u32 s67, s64, 983040
s_waitcnt vmcnt(8)
buffer_load_dwordx4 v28, s[68:71], s67 offen lds
s_add_u32 m0, s63, 24576
s_add_u32 s67, s64, 327680
s_waitcnt vmcnt(8)
buffer_load_dwordx4 v28, s[68:71], s67 offen lds
s_add_u32 m0, s63, 28672
s_add_u32 s67, s64, 1015808
s_waitcnt vmcnt(8)
buffer_load_dwordx4 v28, s[68:71], s67 offen lds
s_add_u32 m0, s63, 32768
s_add_u32 s67, s64, 360448
s_waitcnt vmcnt(8)
buffer_load_dwordx4 v28, s[68:71], s67 offen lds
s_add_u32 m0, s63, 36864
s_add_u32 s67, s64, 1048576
s_waitcnt vmcnt(8)
buffer_load_dwordx4 v28, s[68:71], s67 offen lds
s_add_u32 m0, s63, 40960
s_add_u32 s67, s64, 393216
s_waitcnt vmcnt(8)
buffer_load_dwordx4 v28, s[68:71], s67 offen lds
s_add_u32 m0, s63, 45056
s_add_u32 s67, s64, 1081344
s_waitcnt vmcnt(8)
buffer_load_dwordx4 v28, s[68:71], s67 offen lds
s_waitcnt vmcnt(13)
s_branch L_qx1
L_qx0:
s_waitcnt vmcnt(2)
L_qx1:
s_barrier
s_cmp_lt_u32 s27, 8
s_cbranch_scc1 L_qx2
s_add_u32 m0, s63, 4096
s_add_u32 s67, s64, 917504
s_waitcnt vmcnt(7)
buffer_load_dwordx4 v28, s[68:71], s67 offen lds
s_add_u32 m0, s63, 8192
s_add_u32 s67, s64, 262144
s_waitcnt vmcnt(7)
buffer_load_dwordx4 v28, s[68:71], s67 offen lds
s_add_u32 m0, s63, 12288
s_add_u32 s67, s64, 950272
s_waitcnt vmcnt(7)
buffer_load_dwordx4 v28, s[68:71], s67 offen lds
s_add_u32 m0, s63, 16384
s_add_u32 s67, s64, 294912
s_waitcnt vmcnt(7)
buffer_load_dwordx4 v28, s[68:71], s67 offen lds
s_add_u32 m0, s63, 20480
s_add_u32 s67, s64, 983040
s_waitcnt vmcnt(7)
buffer_load_dwordx4 v28, s[68:71], s67 offen lds
s_add_u32 m0, s63, 24576
s_add_u32 s67, s64, 327680
s_waitcnt vmcnt(7)
buffer_load_dwordx4 v28, s[68:71], s67 offen lds
s_add_u32 m0, s63, 28672
s_add_u32 s67, s64, 1015808
s_waitcnt vmcnt(7)
buffer_load_dwordx4 v28, s[68:71], s67 offen lds
s_add_u32 m0, s63, 32768
s_add_u32 s67, s64, 360448
s_waitcnt vmcnt(7)
buffer_load_dwordx4 v28, s[68:71], s67 offen lds
s_add_u32 m0, s63, 36864
s_add_u32 s67, s64, 1048576
s_waitcnt vmcnt(7)
buffer_load_dwordx4 v28, s[68:71], s67 offen lds
s_add_u32 m0, s63, 40960
s_add_u32 s67, s64, 393216
s_waitcnt vmcnt(7)
buffer_load_dwordx4 v28, s[68:71], s67 offen lds
s_add_u32 m0, s63, 45056
s_add_u32 s67, s64, 1081344
s_waitcnt vmcnt(7)
buffer_load_dwordx4 v28, s[68:71], s67 offen lds
L_qx2:
s_cmp_lt_u32 s27, 8
s_cbranch_scc0 L_dq
s_mov_b32 s31, 0
LW3:
ds_read_b32 v8, v14
s_add_u32 s31, s31, 1
s_waitcnt lgkmcnt(0)
v_cmp_le_u32 vcc, 1, v8
s_cmp_lt_u32 s31, 524288
s_cbranch_scc0 LD3
s_cbranch_vccz LW3
LD3:
L_dq:
s_cmp_lt_u32 s27, 8
s_cselect_b32 s19, 4, s52
s_add_u32 m0, s63, 49152
s_add_u32 s67, s64, 425984
s_waitcnt vmcnt(7)
buffer_load_dwordx4 v28, s[68:71], s67 offen lds
s_add_u32 m0, s63, 53248
s_add_u32 s67, s64, 1114112
s_waitcnt vmcnt(7)
buffer_load_dwordx4 v28, s[68:71], s67 offen lds
s_add_u32 m0, s63, 57344
s_add_u32 s67, s64, 458752
s_waitcnt vmcnt(7)
buffer_load_dwordx4 v28, s[68:71], s67 offen lds
s_add_u32 m0, s63, 61440
s_add_u32 s67, s64, 1146880
s_waitcnt vmcnt(7)
buffer_load_dwordx4 v28, s[68:71], s67 offen lds
s_add_u32 m0, s63, 65536
s_add_u32 s67, s64, 491520
s_waitcnt vmcnt(7)
buffer_load_dwordx4 v28, s[68:71], s67 offen lds
s_add_u32 m0, s63, 69632
s_add_u32 s67, s64, 1179648
s_waitcnt vmcnt(7)
buffer_load_dwordx4 v28, s[68:71], s67 offen lds
s_add_u32 m0, s63, 73728
s_add_u32 s67, s64, 524288
s_waitcnt vmcnt(7)
buffer_load_dwordx4 v28, s[68:71], s67 offen lds
s_add_u32 m0, s63, 77824
s_add_u32 s67, s64, 1212416
s_waitcnt vmcnt(7)
buffer_load_dwordx4 v28, s[68:71], s67 offen lds
s_add_u32 m0, s63, 81920
s_add_u32 s67, s64, 557056
s_waitcnt vmcnt(7)
buffer_load_dwordx4 v28, s[68:71], s67 offen lds
s_add_u32 m0, s63, 86016
s_add_u32 s67, s64, 1245184
s_waitcnt vmcnt(7)
buffer_load_dwordx4 v28, s[68:71], s67 offen lds
s_add_u32 m0, s63, 90112
s_add_u32 s67, s64, 589824
s_waitcnt vmcnt(7)
buffer_load_dwordx4 v28, s[68:71], s67 offen lds
s_add_u32 m0, s63, 94208
s_add_u32 s67, s64, 1277952
s_waitcnt vmcnt(7)
buffer_load_dwordx4 v28, s[68:71], s67 offen lds
s_cmp_lt_u32 s19, 1
s_cbranch_scc0 L_np
buffer_load_dwordx2 v[8:9], v12, s[44:47], s79 offen sc1
L_np:
s_cmp_lt_u32 s52, 1
s_cbranch_scc0 L_s0
s_cmp_lt_u32 s27, 8
s_cbranch_scc1 L_sq
s_waitcnt vmcnt(0)
v_cmp_eq_u64 vcc, s[22:23], v[8:9]
s_nop 1
s_cmp_eq_u64 vcc, -1
s_cbranch_scc1 L_s0
s_branch L_sp
L_sq:
L_sp:
s_mov_b32 s67, 0
PL4:
buffer_load_dwordx2 v[8:9], v12, s[44:47], s79 offen sc1
s_waitcnt vmcnt(0)
v_cmp_eq_u64 vcc, s[22:23], v[8:9]
s_add_u32 s67, s67, 1
s_nop 0
s_cmp_eq_u64 vcc, -1
s_cbranch_scc1 PD4
s_cmp_lt_u32 s67, 524288
s_cbranch_scc1 PL4
PD4:
L_s0:
s_waitcnt vmcnt(12)
s_barrier
s_waitcnt vmcnt(0)
s_barrier
ds_write_b128 v30, v[32:35] offset:49152
ds_write_b128 v30, v[36:39] offset:53248
ds_write_b128 v30, v[40:43] offset:57344
ds_write_b128 v30, v[44:47] offset:61440
ds_write_b128 v15, v[48:51] offset:0
ds_write_b128 v15, v[52:55] offset:4096
ds_write_b128 v15, v[56:59] offset:8192
ds_write_b128 v15, v[60:63] offset:12288
ds_write_b128 v15, v[64:67] offset:16384
ds_write_b128 v15, v[68:71] offset:20480
ds_write_b128 v29, v[72:75] offset:0
ds_write_b128 v29, v[76:79] offset:4096
ds_write_b128 v29, v[80:83] offset:8192
ds_write_b128 v29, v[84:87] offset:12288
ds_write_b128 v29, v[88:91] offset:16384
ds_write_b128 v29, v[92:95] offset:20480
ds_write_b128 v30, v[96:99] offset:32768
ds_write_b128 v30, v[100:103] offset:36864
ds_write_b128 v30, v[104:107] offset:40960
ds_write_b128 v30, v[108:111] offset:45056
s_waitcnt lgkmcnt(0)
s_barrier
s_cmp_eq_u32 s52, 0
s_cbranch_scc0 L_o2
s_mov_b32 s67, 0
PL5:
buffer_load_dwordx2 v[8:9], v13, s[44:47], s18 offen sc1
s_waitcnt vmcnt(0)
v_cmp_eq_u64 vcc, s[22:23], v[8:9]
s_add_u32 s67, s67, 1
s_nop 0
s_cmp_eq_u64 vcc, -1
s_cbranch_scc1 PD5
s_cmp_lt_u32 s67, 524288
s_cbranch_scc1 PL5
PD5:
L_o2:
s_barrier
s_lshl_b32 s67, s2, 2
s_add_u32 s67, s67, s52
s_cmp_eq_u32 s67, 0
s_cbranch_scc0 L_fin
s_mov_b32 s67, 11534336
v_mov_b32 v8, s22
v_mov_b32 v9, s23
s_mov_b64 exec, 1
buffer_store_dwordx2 v[8:9], v251, s[44:47], s67 offen sc1
s_mov_b64 exec, -1
s_branch L_fin
L_exit:
s_endpgm
M_start:
s_and_b32 s30, s2, 1
s_lshr_b32 s31, s2, 3
s_bfe_u32 s52, s2, 0x20001
s_lshl_b32 s30, s30, 5
s_add_u32 s30, s30, s31
s_cmp_eq_u32 s52, 3
s_cselect_b32 s54, 52, 43
s_cselect_b32 s55, 5, 6
s_cselect_b32 s56, 55, 54
s_mul_i32 s26, s30, s54
s_lshr_b32 s26, s26, 8
s_mul_i32 s31, s26, s55
s_sub_u32 s27, s30, s31
s_sub_u32 s57, s30, s56
s_cmp_ge_u32 s57, 5
s_cselect_b32 s58, 10, 9
s_cselect_b32 s31, 5, 0
s_sub_u32 s59, s57, s31
s_and_b32 s60, s57, 1
s_add_u32 s60, s60, 9
s_lshr_b32 s61, s57, 1
s_cmp_eq_u32 s52, 3
s_cselect_b32 s58, s60, s58
s_cselect_b32 s59, 5, s59
s_cselect_b32 s61, s61, s52
s_cmp_lt_u32 s30, s56
s_cselect_b32 s26, s26, s58
s_cselect_b32 s27, s27, s59
s_cselect_b32 s52, s52, s61
s_lshl_b32 s52, s52, 1
s_add_u32 s31, s52, 6
s_cmp_lt_u32 s27, 2
s_cselect_b32 s31, 0, s31
s_add_u32 s27, s27, s52
s_add_u32 s27, s27, s31
s_min_u32 s27, s27, 23
s_lshr_b32 s52, s28, 1
s_and_b32 s53, s28, 1
v_and_b32 v2, 31, v0
v_lshrrev_b32 v3, 5, v0
v_bfe_u32 v4, v0, 1, 3
v_and_b32 v14, 15, v0
v_lshrrev_b32 v15, 4, v0
s_mul_i32 s54, s52, 96
s_cmp_lt_u32 s27, 8
s_cselect_b32 s54, 0, s54
v_add_u32 v5, s54, v14
v_lshlrev_b32 v6, 7, v5
v_xor_b32 v7, v15, v4
v_lshl_add_u32 v216, v7, 4, v6
v_xor_b32 v217, 64, v216
v_lshlrev_b32 v220, 2, v5
v_add_u32 v220, 159744, v220
v_bfe_u32 v8, v0, 4, 1
v_bfe_u32 v9, v0, 2, 2
v_and_b32 v10, 3, v0
v_lshl_add_u32 v11, v15, 3, v9
s_mov_b32 s63, 0
s_mov_b32 s66, 0
s_mov_b32 s65, 49152
v_and_b32 v12, 2, v9
v_or_b32 v12, v12, v8
v_lshlrev_b32 v12, 5, v12
v_lshl_add_u32 v12, v11, 7, v12
v_lshl_add_u32 v12, v10, 3, v12
s_lshl_b32 s77, s52, 12
s_add_u32 s57, s77, 98304
v_add_u32 v244, s57, v12
v_xor_b32 v245, 32, v244
v_xor_b32 v246, 64, v244
v_xor_b32 v247, 96, v244
v_lshlrev_b32 v12, 4, v14
v_lshl_add_u32 v248, v15, 9, v12
s_lshl_b32 s79, s52, 30
s_and_b32 s60, s2, 7
s_lshl_b32 s60, s60, 2
s_lshr_b32 s62, s2, 6
s_add_u32 s60, s60, s62
s_lshl_b32 s60, s60, 1
s_add_u32 s60, s60, s53
s_mul_i32 s60, s60, 132096
s_mul_i32 s57, s52, 43008
s_add_u32 s76, s60, s57
s_add_u32 s74, s60, 86016
s_lshl_b32 s57, s52, 14
s_add_u32 s78, s60, s57
s_add_u32 s78, s78, 98304
s_lshl_b32 s56, s53, 5
v_add_u32 v12, s56, v14
v_lshlrev_b32 v12, 8, v12
v_bfe_u32 v13, v0, 1, 1
v_xor_b32 v13, v13, v8
v_lshl_add_u32 v12, v13, 7, v12
v_and_b32 v13, 7, v0
v_xor_b32 v13, v13, v3
v_lshl_add_u32 v12, v13, 4, v12
s_mul_i32 s56, s52, 16384
s_add_u32 s56, s56, 24576
v_add_u32 v250, s56, v12
v_mov_b32 v240, 160512
v_mov_b32 v241, 0
ds_write_b32 v240, v241
s_waitcnt lgkmcnt(0)
s_mov_b32 s67, 11534336
s_load_dwordx2 s[22:23], s[24:25], s67
s_mov_b64 exec, 0
s_cmp_eq_u32 s28, 0
s_cbranch_scc1 WS_0
s_cmp_eq_u32 s28, 1
s_cbranch_scc1 WS_1
s_cmp_eq_u32 s28, 2
s_cbranch_scc1 WS_2
s_branch WS_3
WRET:
s_mov_b64 exec, -1
WDONE:
WS_2:
s_cbranch_execz WS_6
s_mov_b32 s44, s24
s_and_b32 s45, s25, 0xffff
s_mov_b32 s46, 16777216
s_mov_b32 s47, 0x00020000
s_mov_b32 s48, s20
s_and_b32 s49, s21, 0xffff
s_mov_b32 s50, 2097152
s_mov_b32 s51, 0x00020000
v_lshrrev_b32 v12, 3, v0
s_lshl_b32 s42, s28, 3
v_add_u32 v12, s42, v12
v_and_b32 v13, 7, v0
v_and_b32 v254, 7, v12
v_xor_b32 v254, v254, v13
v_bfe_u32 v255, v12, 1, 1
v_lshl_or_b32 v254, v255, 3, v254
v_lshlrev_b32 v254, 4, v254
v_lshl_add_u32 v254, v12, 8, v254
v_lshlrev_b32 v12, 10, v12
v_lshl_add_u32 v255, v13, 4, v12
s_and_b32 s42, s2, 7
s_lshl_b32 s42, s42, 2
s_lshr_b32 s43, s2, 6
s_add_u32 s42, s42, s43
s_bfe_u32 s43, s2, 0x30003
s_lshl_b32 s43, s43, 7
s_lshl_b32 s42, s42, 16
s_add_u32 s42, s42, s43
s_cmp_lt_u32 s27, 8
s_cbranch_scc1 M_qkv
v_mul_u32_u24 v13, 192, v11
v_lshl_add_u32 v13, v10, 3, v13
v_add_u32 v13, 24576, v13
s_mul_i32 s54, s53, 3
v_xor_b32 v12, s54, v8
v_lshl_add_u32 v218, v12, 5, v13
s_add_u32 s54, s54, 1
v_xor_b32 v12, s54, v8
v_lshl_add_u32 v219, v12, 5, v13
s_lshl_b32 s59, s26, 1
s_add_u32 s59, s59, s52
s_mul_i32 s56, s59, 387
s_lshl_b32 s59, s59, 11
s_sub_u32 s60, s27, 8
s_lshl_b32 s60, s60, 1
s_add_u32 s60, s60, s53
s_mul_i32 s57, s60, 3
s_add_u32 s56, s56, s57
s_lshl_b32 s68, s56, 10
s_add_u32 s69, s68, 132096
s_add_u32 s70, s68, 264192
s_cmp_eq_u32 s59, 43008
s_cselect_b32 s32, 0, s46
s_cmp_ge_u32 s60, 29
s_cselect_b32 s57, 0x40000000, 0
v_add_u32 v221, s57, v251
s_cmp_ge_u32 s60, 28
s_cselect_b32 s57, 0x40000000, 0
v_add_u32 v222, s57, v251
s_mov_b32 s34, s32
s_mov_b32 s32, s44
s_mov_b32 s33, s45
s_mov_b32 s35, 0x00020000
s_lshl_b32 s60, s60, 6
s_add_u32 s71, s59, s60
s_add_u32 s71, s71, 10485760
s_lshl_b32 s71, s26, 5
s_add_u32 s71, s71, s27
s_lshl_b32 s71, s71, 6
s_add_u32 s71, s71, 10485248
s_mov_b32 s30, 3216550459
s_mov_b32 s31, 3216550459
v_mov_b32 v241, 1
s_waitcnt lgkmcnt(0)
s_add_u32 s22, s22, 0x7f4a7c15
s_addc_u32 s23, s23, 0x9e3779b9
v_mov_b32 v252, s22
v_mov_b32 v253, s23
s_setprio 2
s_branch M_b0_ffn
.p2align 6
.fill ((64 - ((M_loop_ffn - M_b0_ffn) & 63)) & 63) / 4, 4, 0xbf800000
M_b0_ffn:
s_barrier
M_head_ffn:
ds_read_b64_tr_b16 v[144:145], v218 offset:0
ds_read_b64_tr_b16 v[146:147], v218 offset:768
ds_read_b128 v[168:171], v216 offset:0
ds_read_b128 v[172:175], v216 offset:2048
ds_read_b128 v[176:179], v216 offset:4096
ds_read_b128 v[180:183], v216 offset:6144
ds_read_b128 v[184:187], v216 offset:8192
ds_read_b128 v[188:191], v216 offset:10240
ds_read_b64_tr_b16 v[148:149], v218 offset:12288
ds_read_b64_tr_b16 v[150:151], v218 offset:13056
ds_read_b64_tr_b16 v[152:153], v219 offset:0
ds_read_b64_tr_b16 v[154:155], v219 offset:768
s_waitcnt lgkmcnt(9)
v_mfma_f32_16x16x32_bf16 v[0:3], v[144:147], v[168:171], 0
ds_read_b64_tr_b16 v[156:157], v219 offset:12288
s_waitcnt lgkmcnt(9)
v_mfma_f32_16x16x32_bf16 v[4:7], v[144:147], v[172:175], 0
ds_read_b64_tr_b16 v[158:159], v219 offset:13056
s_waitcnt lgkmcnt(9)
v_mfma_f32_16x16x32_bf16 v[8:11], v[144:147], v[176:179], 0
ds_read_b64_tr_b16 v[160:161], v218 offset:64
s_cmp_eq_u32 s63, 98304
s_waitcnt lgkmcnt(9)
v_mfma_f32_16x16x32_bf16 v[12:15], v[144:147], v[180:183], 0
ds_read_b64_tr_b16 v[162:163], v218 offset:832
s_cselect_b32 s64, 4294868992, s65
s_waitcnt lgkmcnt(9)
v_mfma_f32_16x16x32_bf16 v[16:19], v[144:147], v[184:187], 0
ds_read_b64_tr_b16 v[164:165], v218 offset:12352
s_add_u32 s63, s63, s64
s_waitcnt lgkmcnt(9)
v_mfma_f32_16x16x32_bf16 v[20:23], v[144:147], v[188:191], 0
ds_read_b64_tr_b16 v[166:167], v218 offset:13120
s_add_u32 s66, s66, 1
s_waitcnt lgkmcnt(8)
v_mfma_f32_16x16x32_bf16 v[44:47], v[148:151], v[188:191], 0
s_cmp_lt_u32 s66, 8
v_mfma_f32_16x16x32_bf16 v[40:43], v[148:151], v[184:187], 0
v_mfma_f32_16x16x32_bf16 v[36:39], v[148:151], v[180:183], 0
v_mfma_f32_16x16x32_bf16 v[32:35], v[148:151], v[176:179], 0
v_mfma_f32_16x16x32_bf16 v[28:31], v[148:151], v[172:175], 0
v_mfma_f32_16x16x32_bf16 v[24:27], v[148:151], v[168:171], 0
s_waitcnt lgkmcnt(6)
v_mfma_f32_16x16x32_bf16 v[48:51], v[152:155], v[168:171], 0
v_mfma_f32_16x16x32_bf16 v[52:55], v[152:155], v[172:175], 0
v_mfma_f32_16x16x32_bf16 v[56:59], v[152:155], v[176:179], 0
v_mfma_f32_16x16x32_bf16 v[60:63], v[152:155], v[180:183], 0
v_mfma_f32_16x16x32_bf16 v[64:67], v[152:155], v[184:187], 0
v_mfma_f32_16x16x32_bf16 v[68:71], v[152:155], v[188:191], 0
s_waitcnt lgkmcnt(4)
v_mfma_f32_16x16x32_bf16 v[92:95], v[156:159], v[188:191], 0
v_mfma_f32_16x16x32_bf16 v[88:91], v[156:159], v[184:187], 0
v_mfma_f32_16x16x32_bf16 v[84:87], v[156:159], v[180:183], 0
v_mfma_f32_16x16x32_bf16 v[80:83], v[156:159], v[176:179], 0
v_mfma_f32_16x16x32_bf16 v[76:79], v[156:159], v[172:175], 0
v_mfma_f32_16x16x32_bf16 v[72:75], v[156:159], v[168:171], 0
s_waitcnt lgkmcnt(2)
v_mfma_f32_16x16x32_bf16 v[96:99], v[160:163], v[168:171], 0
v_mfma_f32_16x16x32_bf16 v[100:103], v[160:163], v[172:175], 0
v_mfma_f32_16x16x32_bf16 v[104:107], v[160:163], v[176:179], 0
v_mfma_f32_16x16x32_bf16 v[108:111], v[160:163], v[180:183], 0
v_mfma_f32_16x16x32_bf16 v[112:115], v[160:163], v[184:187], 0
v_mfma_f32_16x16x32_bf16 v[116:119], v[160:163], v[188:191], 0
s_waitcnt lgkmcnt(0)
v_mfma_f32_16x16x32_bf16 v[140:143], v[164:167], v[188:191], 0
v_mfma_f32_16x16x32_bf16 v[136:139], v[164:167], v[184:187], 0
s_waitcnt lgkmcnt(0)
s_barrier
v_mfma_f32_16x16x32_bf16 v[132:135], v[164:167], v[180:183], 0
ds_read_b64_tr_b16 v[144:145], v218 offset:6144
v_mfma_f32_16x16x32_bf16 v[128:131], v[164:167], v[176:179], 0
ds_read_b64_tr_b16 v[146:147], v218 offset:6912
v_mfma_f32_16x16x32_bf16 v[124:127], v[164:167], v[172:175], 0
ds_read_b128 v[192:195], v217 offset:0
v_mfma_f32_16x16x32_bf16 v[120:123], v[164:167], v[168:171], 0
ds_read_b128 v[196:199], v217 offset:2048
ds_read_b128 v[200:203], v217 offset:4096
ds_read_b128 v[204:207], v217 offset:6144
ds_read_b128 v[208:211], v217 offset:8192
ds_read_b128 v[212:215], v217 offset:10240
ds_read_b64_tr_b16 v[148:149], v218 offset:18432
ds_read_b64_tr_b16 v[150:151], v218 offset:19200
ds_read_b64_tr_b16 v[152:153], v219 offset:6144
ds_read_b64_tr_b16 v[154:155], v219 offset:6912
ds_read_b64_tr_b16 v[156:157], v219 offset:18432
ds_read_b64_tr_b16 v[158:159], v219 offset:19200
ds_read_b64_tr_b16 v[160:161], v218 offset:6208
ds_read_b64_tr_b16 v[162:163], v218 offset:6976
M_loop_ffn:
s_waitcnt lgkmcnt(2)
v_mfma_f32_16x16x32_bf16 v[0:3], v[144:147], v[192:195], v[0:3]
ds_read_b64_tr_b16 v[164:165], v218 offset:18496
v_mfma_f32_16x16x32_bf16 v[4:7], v[144:147], v[196:199], v[4:7]
ds_read_b64_tr_b16 v[166:167], v218 offset:19264
v_mfma_f32_16x16x32_bf16 v[8:11], v[144:147], v[200:203], v[8:11]
v_add_u32 v216, s64, v216
v_mfma_f32_16x16x32_bf16 v[12:15], v[144:147], v[204:207], v[12:15]
v_add_u32 v217, s64, v217
v_mfma_f32_16x16x32_bf16 v[16:19], v[144:147], v[208:211], v[16:19]
v_add_u32 v218, s64, v218
v_mfma_f32_16x16x32_bf16 v[20:23], v[144:147], v[212:215], v[20:23]
v_add_u32 v219, s64, v219
v_mfma_f32_16x16x32_bf16 v[44:47], v[148:151], v[212:215], v[44:47]
v_mfma_f32_16x16x32_bf16 v[40:43], v[148:151], v[208:211], v[40:43]
v_mfma_f32_16x16x32_bf16 v[36:39], v[148:151], v[204:207], v[36:39]
v_mfma_f32_16x16x32_bf16 v[32:35], v[148:151], v[200:203], v[32:35]
s_waitcnt lgkmcnt(0)
s_barrier
v_mfma_f32_16x16x32_bf16 v[28:31], v[148:151], v[196:199], v[28:31]
ds_read_b64_tr_b16 v[144:145], v218 offset:0
v_mfma_f32_16x16x32_bf16 v[24:27], v[148:151], v[192:195], v[24:27]
ds_read_b64_tr_b16 v[146:147], v218 offset:768
v_mfma_f32_16x16x32_bf16 v[48:51], v[152:155], v[192:195], v[48:51]
ds_read_b128 v[168:171], v216 offset:0
v_mfma_f32_16x16x32_bf16 v[52:55], v[152:155], v[196:199], v[52:55]
ds_read_b128 v[172:175], v216 offset:2048
v_mfma_f32_16x16x32_bf16 v[56:59], v[152:155], v[200:203], v[56:59]
ds_read_b128 v[176:179], v216 offset:4096
v_mfma_f32_16x16x32_bf16 v[60:63], v[152:155], v[204:207], v[60:63]
ds_read_b128 v[180:183], v216 offset:6144
v_mfma_f32_16x16x32_bf16 v[64:67], v[152:155], v[208:211], v[64:67]
ds_read_b128 v[184:187], v216 offset:8192
v_mfma_f32_16x16x32_bf16 v[68:71], v[152:155], v[212:215], v[68:71]
ds_read_b128 v[188:191], v216 offset:10240
v_mfma_f32_16x16x32_bf16 v[92:95], v[156:159], v[212:215], v[92:95]
ds_read_b64_tr_b16 v[148:149], v218 offset:12288
v_mfma_f32_16x16x32_bf16 v[88:91], v[156:159], v[208:211], v[88:91]
ds_read_b64_tr_b16 v[150:151], v218 offset:13056
v_mfma_f32_16x16x32_bf16 v[84:87], v[156:159], v[204:207], v[84:87]
ds_read_b64_tr_b16 v[152:153], v219 offset:0
v_mfma_f32_16x16x32_bf16 v[80:83], v[156:159], v[200:203], v[80:83]
ds_read_b64_tr_b16 v[154:155], v219 offset:768
v_mfma_f32_16x16x32_bf16 v[76:79], v[156:159], v[196:199], v[76:79]
v_mfma_f32_16x16x32_bf16 v[72:75], v[156:159], v[192:195], v[72:75]
v_mfma_f32_16x16x32_bf16 v[96:99], v[160:163], v[192:195], v[96:99]
ds_read_b64_tr_b16 v[156:157], v219 offset:12288
v_mfma_f32_16x16x32_bf16 v[100:103], v[160:163], v[196:199], v[100:103]
ds_read_b64_tr_b16 v[158:159], v219 offset:13056
v_mfma_f32_16x16x32_bf16 v[104:107], v[160:163], v[200:203], v[104:107]
v_mfma_f32_16x16x32_bf16 v[108:111], v[160:163], v[204:207], v[108:111]
v_mfma_f32_16x16x32_bf16 v[112:115], v[160:163], v[208:211], v[112:115]
v_mfma_f32_16x16x32_bf16 v[116:119], v[160:163], v[212:215], v[116:119]
v_mfma_f32_16x16x32_bf16 v[140:143], v[164:167], v[212:215], v[140:143]
ds_read_b64_tr_b16 v[160:161], v218 offset:64
v_mfma_f32_16x16x32_bf16 v[136:139], v[164:167], v[208:211], v[136:139]
ds_read_b64_tr_b16 v[162:163], v218 offset:832
v_mfma_f32_16x16x32_bf16 v[132:135], v[164:167], v[204:207], v[132:135]
v_mfma_f32_16x16x32_bf16 v[128:131], v[164:167], v[200:203], v[128:131]
v_mfma_f32_16x16x32_bf16 v[124:127], v[164:167], v[196:199], v[124:127]
v_mfma_f32_16x16x32_bf16 v[120:123], v[164:167], v[192:195], v[120:123]
M_in_ffn:
s_waitcnt lgkmcnt(2)
v_mfma_f32_16x16x32_bf16 v[0:3], v[144:147], v[168:171], v[0:3]
ds_read_b64_tr_b16 v[164:165], v218 offset:12352
v_mfma_f32_16x16x32_bf16 v[4:7], v[144:147], v[172:175], v[4:7]
ds_read_b64_tr_b16 v[166:167], v218 offset:13120
v_mfma_f32_16x16x32_bf16 v[8:11], v[144:147], v[176:179], v[8:11]
s_cmp_eq_u32 s63, 98304
v_mfma_f32_16x16x32_bf16 v[12:15], v[144:147], v[180:183], v[12:15]
s_cselect_b32 s64, 4294868992, s65
v_mfma_f32_16x16x32_bf16 v[16:19], v[144:147], v[184:187], v[16:19]
s_add_u32 s63, s63, s64
v_mfma_f32_16x16x32_bf16 v[20:23], v[144:147], v[188:191], v[20:23]
s_add_u32 s66, s66, 1
v_mfma_f32_16x16x32_bf16 v[44:47], v[148:151], v[188:191], v[44:47]
s_cmp_lt_u32 s66, 8
v_mfma_f32_16x16x32_bf16 v[40:43], v[148:151], v[184:187], v[40:43]
v_mfma_f32_16x16x32_bf16 v[36:39], v[148:151], v[180:183], v[36:39]
v_mfma_f32_16x16x32_bf16 v[32:35], v[148:151], v[176:179], v[32:35]
s_waitcnt lgkmcnt(0)
v_mfma_f32_16x16x32_bf16 v[28:31], v[148:151], v[172:175], v[28:31]
ds_read_b64_tr_b16 v[144:145], v218 offset:6144
v_mfma_f32_16x16x32_bf16 v[24:27], v[148:151], v[168:171], v[24:27]
ds_read_b64_tr_b16 v[146:147], v218 offset:6912
v_mfma_f32_16x16x32_bf16 v[48:51], v[152:155], v[168:171], v[48:51]
ds_read_b128 v[192:195], v217 offset:0
v_mfma_f32_16x16x32_bf16 v[52:55], v[152:155], v[172:175], v[52:55]
ds_read_b128 v[196:199], v217 offset:2048
v_mfma_f32_16x16x32_bf16 v[56:59], v[152:155], v[176:179], v[56:59]
ds_read_b128 v[200:203], v217 offset:4096
v_mfma_f32_16x16x32_bf16 v[60:63], v[152:155], v[180:183], v[60:63]
ds_read_b128 v[204:207], v217 offset:6144
v_mfma_f32_16x16x32_bf16 v[64:67], v[152:155], v[184:187], v[64:67]
ds_read_b128 v[208:211], v217 offset:8192
v_mfma_f32_16x16x32_bf16 v[68:71], v[152:155], v[188:191], v[68:71]
ds_read_b128 v[212:215], v217 offset:10240
v_mfma_f32_16x16x32_bf16 v[92:95], v[156:159], v[188:191], v[92:95]
ds_read_b64_tr_b16 v[148:149], v218 offset:18432
v_mfma_f32_16x16x32_bf16 v[88:91], v[156:159], v[184:187], v[88:91]
ds_read_b64_tr_b16 v[150:151], v218 offset:19200
v_mfma_f32_16x16x32_bf16 v[84:87], v[156:159], v[180:183], v[84:87]
ds_read_b64_tr_b16 v[152:153], v219 offset:6144
v_mfma_f32_16x16x32_bf16 v[80:83], v[156:159], v[176:179], v[80:83]
ds_read_b64_tr_b16 v[154:155], v219 offset:6912
v_mfma_f32_16x16x32_bf16 v[76:79], v[156:159], v[172:175], v[76:79]
v_mfma_f32_16x16x32_bf16 v[72:75], v[156:159], v[168:171], v[72:75]
v_mfma_f32_16x16x32_bf16 v[96:99], v[160:163], v[168:171], v[96:99]
ds_read_b64_tr_b16 v[156:157], v219 offset:18432
v_mfma_f32_16x16x32_bf16 v[100:103], v[160:163], v[172:175], v[100:103]
ds_read_b64_tr_b16 v[158:159], v219 offset:19200
v_mfma_f32_16x16x32_bf16 v[104:107], v[160:163], v[176:179], v[104:107]
v_mfma_f32_16x16x32_bf16 v[108:111], v[160:163], v[180:183], v[108:111]
v_mfma_f32_16x16x32_bf16 v[112:115], v[160:163], v[184:187], v[112:115]
v_mfma_f32_16x16x32_bf16 v[116:119], v[160:163], v[188:191], v[116:119]
v_mfma_f32_16x16x32_bf16 v[140:143], v[164:167], v[188:191], v[140:143]
ds_read_b64_tr_b16 v[160:161], v218 offset:6208
v_mfma_f32_16x16x32_bf16 v[136:139], v[164:167], v[184:187], v[136:139]
ds_read_b64_tr_b16 v[162:163], v218 offset:6976
v_mfma_f32_16x16x32_bf16 v[132:135], v[164:167], v[180:183], v[132:135]
v_mfma_f32_16x16x32_bf16 v[128:131], v[164:167], v[176:179], v[128:131]
v_mfma_f32_16x16x32_bf16 v[124:127], v[164:167], v[172:175], v[124:127]
v_mfma_f32_16x16x32_bf16 v[120:123], v[164:167], v[168:171], v[120:123]
s_cbranch_scc1 M_loop_ffn
WS_3:
s_cbranch_execz WS_7
s_waitcnt lgkmcnt(2)
v_mfma_f32_16x16x32_bf16 v[0:3], v[144:147], v[192:195], v[0:3]
ds_read_b64_tr_b16 v[164:165], v218 offset:18496
v_mfma_f32_16x16x32_bf16 v[4:7], v[144:147], v[196:199], v[4:7]
ds_read_b64_tr_b16 v[166:167], v218 offset:19264
v_mfma_f32_16x16x32_bf16 v[8:11], v[144:147], v[200:203], v[8:11]
ds_read2_b32 v[224:225], v220 offset0:0 offset1:16
v_mfma_f32_16x16x32_bf16 v[12:15], v[144:147], v[204:207], v[12:15]
ds_read2_b32 v[226:227], v220 offset0:32 offset1:48
v_mfma_f32_16x16x32_bf16 v[16:19], v[144:147], v[208:211], v[16:19]
ds_read2_b32 v[228:229], v220 offset0:64 offset1:80
v_mfma_f32_16x16x32_bf16 v[20:23], v[144:147], v[212:215], v[20:23]
v_mfma_f32_16x16x32_bf16 v[44:47], v[148:151], v[212:215], v[44:47]
v_mfma_f32_16x16x32_bf16 v[40:43], v[148:151], v[208:211], v[40:43]
v_mfma_f32_16x16x32_bf16 v[36:39], v[148:151], v[204:207], v[36:39]
v_mfma_f32_16x16x32_bf16 v[32:35], v[148:151], v[200:203], v[32:35]
v_mfma_f32_16x16x32_bf16 v[28:31], v[148:151], v[196:199], v[28:31]
s_waitcnt lgkmcnt(0)
v_mfma_f32_16x16x32_bf16 v[24:27], v[148:151], v[192:195], v[24:27]
v_mfma_f32_16x16x32_bf16 v[48:51], v[152:155], v[192:195], v[48:51]
v_mfma_f32_16x16x32_bf16 v[52:55], v[152:155], v[196:199], v[52:55]
M_kend_ffn:
v_mfma_f32_16x16x32_bf16 v[56:59], v[152:155], v[200:203], v[56:59]
v_mul_f32 v168, s30, v0
v_mul_f32 v169, s30, v1
v_mfma_f32_16x16x32_bf16 v[60:63], v[152:155], v[204:207], v[60:63]
v_exp_f32 v168, v168
v_mfma_f32_16x16x32_bf16 v[64:67], v[152:155], v[208:211], v[64:67]
v_exp_f32 v169, v169
v_mfma_f32_16x16x32_bf16 v[68:71], v[152:155], v[212:215], v[68:71]
v_mul_f32 v170, s30, v2
v_mul_f32 v171, s30, v3
v_mfma_f32_16x16x32_bf16 v[92:95], v[156:159], v[212:215], v[92:95]
v_exp_f32 v170, v170
v_mfma_f32_16x16x32_bf16 v[88:91], v[156:159], v[208:211], v[88:91]
v_exp_f32 v171, v171
v_mfma_f32_16x16x32_bf16 v[84:87], v[156:159], v[204:207], v[84:87]
v_mul_f32 v172, s30, v4
v_mul_f32 v173, s30, v5
v_mfma_f32_16x16x32_bf16 v[80:83], v[156:159], v[200:203], v[80:83]
v_exp_f32 v172, v172
v_mfma_f32_16x16x32_bf16 v[76:79], v[156:159], v[196:199], v[76:79]
v_exp_f32 v173, v173
v_mfma_f32_16x16x32_bf16 v[72:75], v[156:159], v[192:195], v[72:75]
v_mul_f32 v174, s30, v6
v_mul_f32 v175, s30, v7
v_mfma_f32_16x16x32_bf16 v[96:99], v[160:163], v[192:195], v[96:99]
v_exp_f32 v174, v174
v_mfma_f32_16x16x32_bf16 v[100:103], v[160:163], v[196:199], v[100:103]
v_exp_f32 v175, v175
v_mfma_f32_16x16x32_bf16 v[104:107], v[160:163], v[200:203], v[104:107]
v_fma_f32 v168, v168, v224, v224
v_fma_f32 v169, v169, v224, v224
v_mfma_f32_16x16x32_bf16 v[108:111], v[160:163], v[204:207], v[108:111]
v_rcp_f32 v168, v168
v_mfma_f32_16x16x32_bf16 v[112:115], v[160:163], v[208:211], v[112:115]
v_rcp_f32 v169, v169
v_mfma_f32_16x16x32_bf16 v[116:119], v[160:163], v[212:215], v[116:119]
v_fma_f32 v170, v170, v224, v224
v_fma_f32 v171, v171, v224, v224
v_mfma_f32_16x16x32_bf16 v[140:143], v[164:167], v[212:215], v[140:143]
v_rcp_f32 v170, v170
v_mfma_f32_16x16x32_bf16 v[136:139], v[164:167], v[208:211], v[136:139]
v_rcp_f32 v171, v171
v_mfma_f32_16x16x32_bf16 v[132:135], v[164:167], v[204:207], v[132:135]
v_fma_f32 v172, v172, v225, v225
v_fma_f32 v173, v173, v225, v225
v_mfma_f32_16x16x32_bf16 v[128:131], v[164:167], v[200:203], v[128:131]
v_rcp_f32 v172, v172
v_mfma_f32_16x16x32_bf16 v[124:127], v[164:167], v[196:199], v[124:127]
v_rcp_f32 v173, v173
v_mfma_f32_16x16x32_bf16 v[120:123], v[164:167], v[192:195], v[120:123]
v_fma_f32 v174, v174, v225, v225
v_fma_f32 v175, v175, v225, v225
v_rcp_f32 v174, v174
v_rcp_f32 v175, v175
v_pk_mul_f32 v[0:1], v[0:1], v[24:25]
v_pk_mul_f32 v[2:3], v[2:3], v[26:27]
v_pk_mul_f32 v[4:5], v[4:5], v[28:29]
v_pk_mul_f32 v[6:7], v[6:7], v[30:31]
v_pk_mul_f32 v[0:1], v[0:1], v[168:169]
v_pk_mul_f32 v[2:3], v[2:3], v[170:171]
v_pk_mul_f32 v[4:5], v[4:5], v[172:173]
v_pk_mul_f32 v[6:7], v[6:7], v[174:175]
v_cvt_pk_bf16_f32 v176, v0, v1
v_cvt_pk_bf16_f32 v177, v2, v3
v_cvt_pk_bf16_f32 v178, v4, v5
v_cvt_pk_bf16_f32 v179, v6, v7
v_pk_mul_f32 v[180:181], v[8:9], s[30:31]
v_permlane16_swap_b32 v176, v178
v_exp_f32 v180, v180
v_permlane16_swap_b32 v177, v179
v_exp_f32 v181, v181
buffer_store_dwordx4 v[176:179], v221, s[44:47], s68 offen offset:0 sc1
v_pk_mul_f32 v[182:183], v[10:11], s[30:31]
v_pk_mul_f32 v[184:185], v[12:13], s[30:31]
v_exp_f32 v182, v182
v_pk_mul_f32 v[186:187], v[14:15], s[30:31]
v_exp_f32 v183, v183
v_pk_fma_f32 v[180:181], v[180:181], v[226:227], v[226:227] op_sel_hi:[1,0,0]
v_exp_f32 v184, v184
v_pk_fma_f32 v[182:183], v[182:183], v[226:227], v[226:227] op_sel_hi:[1,0,0]
v_exp_f32 v185, v185
v_pk_mul_f32 v[8:9], v[8:9], v[32:33]
v_exp_f32 v186, v186
v_pk_fma_f32 v[184:185], v[184:185], v[226:227], v[226:227] op_sel:[0,1,1]
v_exp_f32 v187, v187
v_pk_mul_f32 v[10:11], v[10:11], v[34:35]
v_rcp_f32 v180, v180
v_pk_fma_f32 v[186:187], v[186:187], v[226:227], v[226:227] op_sel:[0,1,1]
v_rcp_f32 v181, v181
v_pk_mul_f32 v[12:13], v[12:13], v[36:37]
v_rcp_f32 v182, v182
v_pk_mul_f32 v[14:15], v[14:15], v[38:39]
v_rcp_f32 v183, v183
v_pk_mul_f32 v[8:9], v[8:9], v[180:181]
v_rcp_f32 v184, v184
v_pk_mul_f32 v[10:11], v[10:11], v[182:183]
v_rcp_f32 v185, v185
v_cvt_pk_bf16_f32 v188, v8, v9
v_rcp_f32 v186, v186
v_pk_mul_f32 v[12:13], v[12:13], v[184:185]
v_rcp_f32 v187, v187
v_cvt_pk_bf16_f32 v189, v10, v11
v_pk_mul_f32 v[14:15], v[14:15], v[186:187]
v_cvt_pk_bf16_f32 v190, v12, v13
v_cvt_pk_bf16_f32 v191, v14, v15
v_pk_mul_f32 v[144:145], v[16:17], s[30:31]
v_permlane16_swap_b32 v188, v190
v_exp_f32 v144, v144
v_permlane16_swap_b32 v189, v191
v_exp_f32 v145, v145
buffer_store_dwordx4 v[188:191], v221, s[32:35], s69 offen offset:0 sc1
v_pk_mul_f32 v[146:147], v[18:19], s[30:31]
v_pk_mul_f32 v[148:149], v[20:21], s[30:31]
v_exp_f32 v146, v146
v_pk_mul_f32 v[150:151], v[22:23], s[30:31]
v_exp_f32 v147, v147
v_pk_fma_f32 v[144:145], v[144:145], v[228:229], v[228:229] op_sel_hi:[1,0,0]
v_exp_f32 v148, v148
v_pk_fma_f32 v[146:147], v[146:147], v[228:229], v[228:229] op_sel_hi:[1,0,0]
v_exp_f32 v149, v149
v_pk_mul_f32 v[16:17], v[16:17], v[40:41]
v_exp_f32 v150, v150
v_pk_fma_f32 v[148:149], v[148:149], v[228:229], v[228:229] op_sel:[0,1,1]
v_exp_f32 v151, v151
v_pk_mul_f32 v[18:19], v[18:19], v[42:43]
v_rcp_f32 v144, v144
v_pk_fma_f32 v[150:151], v[150:151], v[228:229], v[228:229] op_sel:[0,1,1]
v_rcp_f32 v145, v145
v_pk_mul_f32 v[20:21], v[20:21], v[44:45]
v_rcp_f32 v146, v146
v_pk_mul_f32 v[22:23], v[22:23], v[46:47]
v_rcp_f32 v147, v147
v_pk_mul_f32 v[16:17], v[16:17], v[144:145]
v_rcp_f32 v148, v148
v_pk_mul_f32 v[18:19], v[18:19], v[146:147]
v_rcp_f32 v149, v149
v_cvt_pk_bf16_f32 v152, v16, v17
v_rcp_f32 v150, v150
v_pk_mul_f32 v[20:21], v[20:21], v[148:149]
v_rcp_f32 v151, v151
v_cvt_pk_bf16_f32 v153, v18, v19
v_pk_mul_f32 v[22:23], v[22:23], v[150:151]
v_cvt_pk_bf16_f32 v154, v20, v21
v_cvt_pk_bf16_f32 v155, v22, v23
v_pk_mul_f32 v[156:157], v[48:49], s[30:31]
v_permlane16_swap_b32 v152, v154
v_exp_f32 v156, v156
v_permlane16_swap_b32 v153, v155
v_exp_f32 v157, v157
buffer_store_dwordx4 v[152:155], v221, s[32:35], s70 offen offset:0 sc1
v_pk_mul_f32 v[158:159], v[50:51], s[30:31]
v_pk_mul_f32 v[160:161], v[52:53], s[30:31]
v_exp_f32 v158, v158
v_pk_mul_f32 v[162:163], v[54:55], s[30:31]
v_exp_f32 v159, v159
v_pk_fma_f32 v[156:157], v[156:157], v[224:225], v[224:225] op_sel_hi:[1,0,0]
v_exp_f32 v160, v160
v_pk_fma_f32 v[158:159], v[158:159], v[224:225], v[224:225] op_sel_hi:[1,0,0]
v_exp_f32 v161, v161
v_pk_mul_f32 v[48:49], v[48:49], v[72:73]
v_exp_f32 v162, v162
v_pk_fma_f32 v[160:161], v[160:161], v[224:225], v[224:225] op_sel:[0,1,1]
v_exp_f32 v163, v163
v_pk_mul_f32 v[50:51], v[50:51], v[74:75]
v_rcp_f32 v156, v156
v_pk_fma_f32 v[162:163], v[162:163], v[224:225], v[224:225] op_sel:[0,1,1]
v_rcp_f32 v157, v157
v_pk_mul_f32 v[52:53], v[52:53], v[76:77]
v_rcp_f32 v158, v158
v_pk_mul_f32 v[54:55], v[54:55], v[78:79]
v_rcp_f32 v159, v159
v_pk_mul_f32 v[48:49], v[48:49], v[156:157]
v_rcp_f32 v160, v160
v_pk_mul_f32 v[50:51], v[50:51], v[158:159]
v_rcp_f32 v161, v161
v_cvt_pk_bf16_f32 v164, v48, v49
v_rcp_f32 v162, v162
v_pk_mul_f32 v[52:53], v[52:53], v[160:161]
v_rcp_f32 v163, v163
v_cvt_pk_bf16_f32 v165, v50, v51
v_pk_mul_f32 v[54:55], v[54:55], v[162:163]
v_cvt_pk_bf16_f32 v166, v52, v53
v_cvt_pk_bf16_f32 v167, v54, v55
v_pk_mul_f32 v[192:193], v[56:57], s[30:31]
v_permlane16_swap_b32 v164, v166
v_exp_f32 v192, v192
v_permlane16_swap_b32 v165, v167
v_exp_f32 v193, v193
buffer_store_dwordx4 v[164:167], v221, s[44:47], s68 offen offset:1024 sc1
v_pk_mul_f32 v[194:195], v[58:59], s[30:31]
v_pk_mul_f32 v[196:197], v[60:61], s[30:31]
v_exp_f32 v194, v194
v_pk_mul_f32 v[198:199], v[62:63], s[30:31]
v_exp_f32 v195, v195
v_pk_fma_f32 v[192:193], v[192:193], v[226:227], v[226:227] op_sel_hi:[1,0,0]
v_exp_f32 v196, v196
v_pk_fma_f32 v[194:195], v[194:195], v[226:227], v[226:227] op_sel_hi:[1,0,0]
v_exp_f32 v197, v197
v_pk_mul_f32 v[56:57], v[56:57], v[80:81]
v_exp_f32 v198, v198
v_pk_fma_f32 v[196:197], v[196:197], v[226:227], v[226:227] op_sel:[0,1,1]
v_exp_f32 v199, v199
v_pk_mul_f32 v[58:59], v[58:59], v[82:83]
v_rcp_f32 v192, v192
v_pk_fma_f32 v[198:199], v[198:199], v[226:227], v[226:227] op_sel:[0,1,1]
v_rcp_f32 v193, v193
v_pk_mul_f32 v[60:61], v[60:61], v[84:85]
v_rcp_f32 v194, v194
v_pk_mul_f32 v[62:63], v[62:63], v[86:87]
v_rcp_f32 v195, v195
v_pk_mul_f32 v[56:57], v[56:57], v[192:193]
v_rcp_f32 v196, v196
v_pk_mul_f32 v[58:59], v[58:59], v[194:195]
v_rcp_f32 v197, v197
v_cvt_pk_bf16_f32 v200, v56, v57
v_rcp_f32 v198, v198
v_pk_mul_f32 v[60:61], v[60:61], v[196:197]
v_rcp_f32 v199, v199
v_cvt_pk_bf16_f32 v201, v58, v59
v_pk_mul_f32 v[62:63], v[62:63], v[198:199]
v_cvt_pk_bf16_f32 v202, v60, v61
v_cvt_pk_bf16_f32 v203, v62, v63
v_pk_mul_f32 v[204:205], v[64:65], s[30:31]
v_permlane16_swap_b32 v200, v202
v_exp_f32 v204, v204
v_permlane16_swap_b32 v201, v203
v_exp_f32 v205, v205
buffer_store_dwordx4 v[200:203], v221, s[32:35], s69 offen offset:1024 sc1
v_pk_mul_f32 v[206:207], v[66:67], s[30:31]
v_pk_mul_f32 v[208:209], v[68:69], s[30:31]
v_exp_f32 v206, v206
v_pk_mul_f32 v[210:211], v[70:71], s[30:31]
v_exp_f32 v207, v207
v_pk_fma_f32 v[204:205], v[204:205], v[228:229], v[228:229] op_sel_hi:[1,0,0]
v_exp_f32 v208, v208
v_pk_fma_f32 v[206:207], v[206:207], v[228:229], v[228:229] op_sel_hi:[1,0,0]
v_exp_f32 v209, v209
v_pk_mul_f32 v[64:65], v[64:65], v[88:89]
v_exp_f32 v210, v210
v_pk_fma_f32 v[208:209], v[208:209], v[228:229], v[228:229] op_sel:[0,1,1]
v_exp_f32 v211, v211
v_pk_mul_f32 v[66:67], v[66:67], v[90:91]
v_rcp_f32 v204, v204
v_pk_fma_f32 v[210:211], v[210:211], v[228:229], v[228:229] op_sel:[0,1,1]
v_rcp_f32 v205, v205
v_pk_mul_f32 v[68:69], v[68:69], v[92:93]
v_rcp_f32 v206, v206
v_pk_mul_f32 v[70:71], v[70:71], v[94:95]
v_rcp_f32 v207, v207
v_pk_mul_f32 v[64:65], v[64:65], v[204:205]
v_rcp_f32 v208, v208
v_pk_mul_f32 v[66:67], v[66:67], v[206:207]
v_rcp_f32 v209, v209
v_cvt_pk_bf16_f32 v212, v64, v65
v_rcp_f32 v210, v210
v_pk_mul_f32 v[68:69], v[68:69], v[208:209]
v_rcp_f32 v211, v211
v_cvt_pk_bf16_f32 v213, v66, v67
v_pk_mul_f32 v[70:71], v[70:71], v[210:211]
v_cvt_pk_bf16_f32 v214, v68, v69
v_cvt_pk_bf16_f32 v215, v70, v71
v_pk_mul_f32 v[168:169], v[96:97], s[30:31]
v_permlane16_swap_b32 v212, v214
v_exp_f32 v168, v168
v_permlane16_swap_b32 v213, v215
v_exp_f32 v169, v169
WS_4:
s_cbranch_execz WS_8
buffer_store_dwordx4 v[212:215], v221, s[32:35], s70 offen offset:1024 sc1
v_pk_mul_f32 v[170:171], v[98:99], s[30:31]
v_pk_mul_f32 v[172:173], v[100:101], s[30:31]
v_exp_f32 v170, v170
v_pk_mul_f32 v[174:175], v[102:103], s[30:31]
v_exp_f32 v171, v171
v_pk_fma_f32 v[168:169], v[168:169], v[224:225], v[224:225] op_sel_hi:[1,0,0]
v_exp_f32 v172, v172
v_pk_fma_f32 v[170:171], v[170:171], v[224:225], v[224:225] op_sel_hi:[1,0,0]
v_exp_f32 v173, v173
v_pk_mul_f32 v[96:97], v[96:97], v[120:121]
v_exp_f32 v174, v174
v_pk_fma_f32 v[172:173], v[172:173], v[224:225], v[224:225] op_sel:[0,1,1]
v_exp_f32 v175, v175
v_pk_mul_f32 v[98:99], v[98:99], v[122:123]
v_rcp_f32 v168, v168
v_pk_fma_f32 v[174:175], v[174:175], v[224:225], v[224:225] op_sel:[0,1,1]
v_rcp_f32 v169, v169
v_pk_mul_f32 v[100:101], v[100:101], v[124:125]
v_rcp_f32 v170, v170
v_pk_mul_f32 v[102:103], v[102:103], v[126:127]
v_rcp_f32 v171, v171
v_pk_mul_f32 v[96:97], v[96:97], v[168:169]
v_rcp_f32 v172, v172
v_pk_mul_f32 v[98:99], v[98:99], v[170:171]
v_rcp_f32 v173, v173
v_cvt_pk_bf16_f32 v176, v96, v97
v_rcp_f32 v174, v174
v_pk_mul_f32 v[100:101], v[100:101], v[172:173]
v_rcp_f32 v175, v175
v_cvt_pk_bf16_f32 v177, v98, v99
v_pk_mul_f32 v[102:103], v[102:103], v[174:175]
v_cvt_pk_bf16_f32 v178, v100, v101
v_cvt_pk_bf16_f32 v179, v102, v103
v_pk_mul_f32 v[180:181], v[104:105], s[30:31]
v_permlane16_swap_b32 v176, v178
v_exp_f32 v180, v180
v_permlane16_swap_b32 v177, v179
v_exp_f32 v181, v181
buffer_store_dwordx4 v[176:179], v222, s[44:47], s68 offen offset:2048 sc1
v_pk_mul_f32 v[182:183], v[106:107], s[30:31]
v_pk_mul_f32 v[184:185], v[108:109], s[30:31]
v_exp_f32 v182, v182
v_pk_mul_f32 v[186:187], v[110:111], s[30:31]
v_exp_f32 v183, v183
v_pk_fma_f32 v[180:181], v[180:181], v[226:227], v[226:227] op_sel_hi:[1,0,0]
v_exp_f32 v184, v184
v_pk_fma_f32 v[182:183], v[182:183], v[226:227], v[226:227] op_sel_hi:[1,0,0]
v_exp_f32 v185, v185
v_pk_mul_f32 v[104:105], v[104:105], v[128:129]
v_exp_f32 v186, v186
v_pk_fma_f32 v[184:185], v[184:185], v[226:227], v[226:227] op_sel:[0,1,1]
v_exp_f32 v187, v187
v_pk_mul_f32 v[106:107], v[106:107], v[130:131]
v_rcp_f32 v180, v180
v_pk_fma_f32 v[186:187], v[186:187], v[226:227], v[226:227] op_sel:[0,1,1]
v_rcp_f32 v181, v181
v_pk_mul_f32 v[108:109], v[108:109], v[132:133]
v_rcp_f32 v182, v182
v_pk_mul_f32 v[110:111], v[110:111], v[134:135]
v_rcp_f32 v183, v183
v_pk_mul_f32 v[104:105], v[104:105], v[180:181]
v_rcp_f32 v184, v184
v_pk_mul_f32 v[106:107], v[106:107], v[182:183]
v_rcp_f32 v185, v185
v_cvt_pk_bf16_f32 v188, v104, v105
v_rcp_f32 v186, v186
v_pk_mul_f32 v[108:109], v[108:109], v[184:185]
v_rcp_f32 v187, v187
v_cvt_pk_bf16_f32 v189, v106, v107
v_pk_mul_f32 v[110:111], v[110:111], v[186:187]
v_cvt_pk_bf16_f32 v190, v108, v109
v_cvt_pk_bf16_f32 v191, v110, v111
v_pk_mul_f32 v[144:145], v[112:113], s[30:31]
v_permlane16_swap_b32 v188, v190
v_exp_f32 v144, v144
v_permlane16_swap_b32 v189, v191
v_exp_f32 v145, v145
buffer_store_dwordx4 v[188:191], v222, s[32:35], s69 offen offset:2048 sc1
v_pk_mul_f32 v[146:147], v[114:115], s[30:31]
v_pk_mul_f32 v[148:149], v[116:117], s[30:31]
v_exp_f32 v146, v146
v_pk_mul_f32 v[150:151], v[118:119], s[30:31]
v_exp_f32 v147, v147
v_pk_fma_f32 v[144:145], v[144:145], v[228:229], v[228:229] op_sel_hi:[1,0,0]
v_exp_f32 v148, v148
v_pk_fma_f32 v[146:147], v[146:147], v[228:229], v[228:229] op_sel_hi:[1,0,0]
v_exp_f32 v149, v149
v_pk_mul_f32 v[112:113], v[112:113], v[136:137]
v_exp_f32 v150, v150
v_pk_fma_f32 v[148:149], v[148:149], v[228:229], v[228:229] op_sel:[0,1,1]
v_exp_f32 v151, v151
v_pk_mul_f32 v[114:115], v[114:115], v[138:139]
v_rcp_f32 v144, v144
v_pk_fma_f32 v[150:151], v[150:151], v[228:229], v[228:229] op_sel:[0,1,1]
v_rcp_f32 v145, v145
v_pk_mul_f32 v[116:117], v[116:117], v[140:141]
v_rcp_f32 v146, v146
v_pk_mul_f32 v[118:119], v[118:119], v[142:143]
v_rcp_f32 v147, v147
v_pk_mul_f32 v[112:113], v[112:113], v[144:145]
v_rcp_f32 v148, v148
v_pk_mul_f32 v[114:115], v[114:115], v[146:147]
v_rcp_f32 v149, v149
v_cvt_pk_bf16_f32 v152, v112, v113
v_rcp_f32 v150, v150
v_pk_mul_f32 v[116:117], v[116:117], v[148:149]
v_rcp_f32 v151, v151
v_cvt_pk_bf16_f32 v153, v114, v115
v_pk_mul_f32 v[118:119], v[118:119], v[150:151]
v_cvt_pk_bf16_f32 v154, v116, v117
v_cvt_pk_bf16_f32 v155, v118, v119
s_nop 0
v_permlane16_swap_b32 v152, v154
v_permlane16_swap_b32 v153, v155
buffer_store_dwordx4 v[152:155], v222, s[32:35], s70 offen offset:2048 sc1
s_cmp_eq_u32 s28, 0
s_waitcnt vmcnt(0)
s_barrier
s_cbranch_scc0 M_nf
s_mov_b64 exec, 1
buffer_store_dwordx2 v[252:253], v251, s[44:47], s71 offen sc1
s_mov_b64 exec, -1
M_nf:
ds_read_b64_tr_b16 v[80:81], v244 offset:0
ds_read_b64_tr_b16 v[82:83], v244 offset:512
ds_read_b64_tr_b16 v[84:85], v245 offset:0
ds_read_b64_tr_b16 v[86:87], v245 offset:512
ds_read_b64_tr_b16 v[88:89], v246 offset:0
ds_read_b64_tr_b16 v[90:91], v246 offset:512
ds_read_b64_tr_b16 v[92:93], v247 offset:0
ds_read_b64_tr_b16 v[94:95], v247 offset:512
ds_read_b64_tr_b16 v[96:97], v244 offset:8192
ds_read_b64_tr_b16 v[98:99], v244 offset:8704
ds_read_b64_tr_b16 v[100:101], v245 offset:8192
ds_read_b64_tr_b16 v[102:103], v245 offset:8704
ds_read_b64_tr_b16 v[104:105], v246 offset:8192
ds_read_b64_tr_b16 v[106:107], v246 offset:8704
ds_read_b64_tr_b16 v[108:109], v247 offset:8192
ds_read_b64_tr_b16 v[110:111], v247 offset:8704
ds_read_b64_tr_b16 v[112:113], v244 offset:16384
ds_read_b64_tr_b16 v[114:115], v244 offset:16896
ds_read_b64_tr_b16 v[116:117], v245 offset:16384
ds_read_b64_tr_b16 v[118:119], v245 offset:16896
ds_read_b64_tr_b16 v[120:121], v246 offset:16384
ds_read_b64_tr_b16 v[122:123], v246 offset:16896
ds_read_b64_tr_b16 v[124:125], v247 offset:16384
ds_read_b64_tr_b16 v[126:127], v247 offset:16896
ds_read_b64_tr_b16 v[128:129], v244 offset:24576
ds_read_b64_tr_b16 v[130:131], v244 offset:25088
ds_read_b64_tr_b16 v[132:133], v245 offset:24576
ds_read_b64_tr_b16 v[134:135], v245 offset:25088
ds_read_b64_tr_b16 v[136:137], v246 offset:24576
ds_read_b64_tr_b16 v[138:139], v246 offset:25088
ds_read_b64_tr_b16 v[140:141], v247 offset:24576
ds_read_b64_tr_b16 v[142:143], v247 offset:25088
ds_read_b64_tr_b16 v[144:145], v244 offset:32768
ds_read_b64_tr_b16 v[146:147], v244 offset:33280
ds_read_b64_tr_b16 v[148:149], v245 offset:32768
ds_read_b64_tr_b16 v[150:151], v245 offset:33280
ds_read_b64_tr_b16 v[152:153], v246 offset:32768
ds_read_b64_tr_b16 v[154:155], v246 offset:33280
ds_read_b64_tr_b16 v[156:157], v247 offset:32768
ds_read_b64_tr_b16 v[158:159], v247 offset:33280
ds_read_b64_tr_b16 v[160:161], v244 offset:40960
ds_read_b64_tr_b16 v[162:163], v244 offset:41472
ds_read_b64_tr_b16 v[164:165], v245 offset:40960
ds_read_b64_tr_b16 v[166:167], v245 offset:41472
ds_read_b64_tr_b16 v[168:169], v246 offset:40960
ds_read_b64_tr_b16 v[170:171], v246 offset:41472
ds_read_b64_tr_b16 v[172:173], v247 offset:40960
ds_read_b64_tr_b16 v[174:175], v247 offset:41472
ds_read_b64_tr_b16 v[176:177], v244 offset:49152
ds_read_b64_tr_b16 v[178:179], v244 offset:49664
ds_read_b64_tr_b16 v[180:181], v245 offset:49152
ds_read_b64_tr_b16 v[182:183], v245 offset:49664
ds_read_b64_tr_b16 v[184:185], v246 offset:49152
ds_read_b64_tr_b16 v[186:187], v246 offset:49664
ds_read_b64_tr_b16 v[188:189], v247 offset:49152
ds_read_b64_tr_b16 v[190:191], v247 offset:49664
s_branch M_s2
M_qkv:
v_and_b32 v12, 2, v9
v_or_b32 v12, v12, v8
v_xor_b32 v12, s28, v12
v_lshlrev_b32 v12, 5, v12
v_lshl_add_u32 v12, v11, 7, v12
v_lshl_add_u32 v12, v10, 3, v12
v_add_u32 v218, 24576, v12
s_lshl_b32 s60, s27, 2
s_add_u32 s60, s60, s28
s_mul_i32 s56, s26, 774
s_add_u32 s56, s56, s60
s_add_u32 s56, s56, 96
s_lshl_b32 s36, s56, 10
s_add_u32 s37, s36, 132096
s_add_u32 s38, s36, 264192
s_add_u32 s39, s36, 396288
s_add_u32 s40, s36, 528384
s_add_u32 s41, s36, 660480
s_lshl_b32 s59, s26, 11
s_lshl_b32 s57, s60, 6
s_add_u32 s71, s59, s57
s_add_u32 s71, s71, 10530816
s_mul_i32 s72, s60, 12672
s_add_u32 s72, s72, 9437184
s_mul_i32 s73, s26, 1152
s_add_u32 s73, s73, s72
s_add_u32 s57, s72, 4608
s_add_u32 s58, s72, 9216
s_cmp_eq_u32 s26, 10
s_cselect_b32 s75, 0, 0x3f803f80
s_cselect_b32 s6, 0, s46
s_mov_b32 s4, s44
s_mov_b32 s5, s45
s_mov_b32 s7, 0x00020000
v_lshlrev_b32 v221, 4, v15
v_mul_u32_u24 v12, 1152, v14
v_add_u32 v222, v12, v221
v_lshl_add_u32 v221, v14, 6, v221
v_mov_b32 v223, 0xffffff00
v_mov_b32 v236, 0x3f803f80
v_mov_b32 v237, 0x3f803f80
v_mov_b32 v238, 0x3f803f80
v_mov_b32 v239, 0x3f803f80
s_mov_b32 s30, 1069066811
s_mov_b32 s31, 1069066811
s_mov_b32 s3, 897988541
v_mov_b32 v241, 1
s_waitcnt lgkmcnt(0)
s_add_u32 s22, s22, 0x7f4a7c15
s_addc_u32 s23, s23, 0x9e3779b9
v_mov_b32 v252, s22
v_mov_b32 v253, s23
s_bfe_u32 s32, s22, 524288
s_bfe_u32 s33, s22, 524296
s_bfe_u32 s34, s22, 524304
s_bfe_u32 s35, s22, 524312
s_setprio 2
s_branch M_b0_qkv
.p2align 6
.fill ((64 - ((M_loop_qkv - M_b0_qkv) & 63)) & 63) / 4, 4, 0xbf800000
M_b0_qkv:
s_barrier
M_head_qkv:
ds_read_b128 v[144:147], v216 offset:0
ds_read_b64_tr_b16 v[192:193], v218 offset:0
ds_read_b64_tr_b16 v[194:195], v218 offset:512
ds_read_b64_tr_b16 v[196:197], v218 offset:8192
ds_read_b64_tr_b16 v[198:199], v218 offset:8704
ds_read_b64_tr_b16 v[200:201], v218 offset:16384
ds_read_b64_tr_b16 v[202:203], v218 offset:16896
ds_read_b128 v[148:151], v216 offset:2048
ds_read_b128 v[152:155], v216 offset:4096
ds_read_b128 v[156:159], v216 offset:6144
ds_read_b128 v[160:163], v216 offset:8192
ds_read_b128 v[164:167], v216 offset:10240
s_waitcnt lgkmcnt(9)
v_mfma_f32_16x16x32_bf16 v[0:3], v[192:195], v[144:147], 0
ds_read_b128 v[168:171], v216 offset:12288
s_waitcnt lgkmcnt(8)
v_mfma_f32_16x16x32_bf16 v[48:51], v[144:147], v[196:199], 0
ds_read_b128 v[172:175], v216 offset:14336
s_waitcnt lgkmcnt(7)
v_mfma_f32_16x16x32_bf16 v[96:99], v[144:147], v[200:203], 0
ds_read_b128 v[176:179], v216 offset:16384
s_cmp_eq_u32 s63, 98304
s_waitcnt lgkmcnt(7)
v_mfma_f32_16x16x32_bf16 v[100:103], v[148:151], v[200:203], 0
ds_read_b128 v[180:183], v216 offset:18432
s_cselect_b32 s64, 4294868992, s65
v_mfma_f32_16x16x32_bf16 v[52:55], v[148:151], v[196:199], 0
ds_read_b128 v[184:187], v216 offset:20480
s_add_u32 s63, s63, s64
v_mfma_f32_16x16x32_bf16 v[4:7], v[192:195], v[148:151], 0
ds_read_b128 v[188:191], v216 offset:22528
s_add_u32 s66, s66, 1
s_waitcnt lgkmcnt(9)
v_mfma_f32_16x16x32_bf16 v[8:11], v[192:195], v[152:155], 0
s_cmp_lt_u32 s66, 8
v_mfma_f32_16x16x32_bf16 v[56:59], v[152:155], v[196:199], 0
v_mfma_f32_16x16x32_bf16 v[104:107], v[152:155], v[200:203], 0
s_waitcnt lgkmcnt(8)
v_mfma_f32_16x16x32_bf16 v[108:111], v[156:159], v[200:203], 0
v_mfma_f32_16x16x32_bf16 v[60:63], v[156:159], v[196:199], 0
v_mfma_f32_16x16x32_bf16 v[12:15], v[192:195], v[156:159], 0
s_waitcnt lgkmcnt(7)
v_mfma_f32_16x16x32_bf16 v[16:19], v[192:195], v[160:163], 0
v_mfma_f32_16x16x32_bf16 v[64:67], v[160:163], v[196:199], 0
v_mfma_f32_16x16x32_bf16 v[112:115], v[160:163], v[200:203], 0
s_waitcnt lgkmcnt(6)
v_mfma_f32_16x16x32_bf16 v[116:119], v[164:167], v[200:203], 0
v_mfma_f32_16x16x32_bf16 v[68:71], v[164:167], v[196:199], 0
v_mfma_f32_16x16x32_bf16 v[20:23], v[192:195], v[164:167], 0
s_waitcnt lgkmcnt(5)
v_mfma_f32_16x16x32_bf16 v[24:27], v[192:195], v[168:171], 0
v_mfma_f32_16x16x32_bf16 v[72:75], v[168:171], v[196:199], 0
v_mfma_f32_16x16x32_bf16 v[120:123], v[168:171], v[200:203], 0
s_waitcnt lgkmcnt(4)
v_mfma_f32_16x16x32_bf16 v[124:127], v[172:175], v[200:203], 0
v_mfma_f32_16x16x32_bf16 v[76:79], v[172:175], v[196:199], 0
v_mfma_f32_16x16x32_bf16 v[28:31], v[192:195], v[172:175], 0
s_waitcnt lgkmcnt(3)
v_mfma_f32_16x16x32_bf16 v[32:35], v[192:195], v[176:179], 0
v_mfma_f32_16x16x32_bf16 v[80:83], v[176:179], v[196:199], 0
v_mfma_f32_16x16x32_bf16 v[128:131], v[176:179], v[200:203], 0
s_waitcnt lgkmcnt(2)
v_mfma_f32_16x16x32_bf16 v[132:135], v[180:183], v[200:203], 0
v_mfma_f32_16x16x32_bf16 v[84:87], v[180:183], v[196:199], 0
v_mfma_f32_16x16x32_bf16 v[36:39], v[192:195], v[180:183], 0
s_waitcnt lgkmcnt(1)
v_mfma_f32_16x16x32_bf16 v[40:43], v[192:195], v[184:187], 0
v_mfma_f32_16x16x32_bf16 v[88:91], v[184:187], v[196:199], 0
s_waitcnt lgkmcnt(0)
s_barrier
v_mfma_f32_16x16x32_bf16 v[136:139], v[184:187], v[200:203], 0
ds_read_b128 v[144:147], v217 offset:0
v_mfma_f32_16x16x32_bf16 v[140:143], v[188:191], v[200:203], 0
ds_read_b128 v[148:151], v217 offset:2048
v_mfma_f32_16x16x32_bf16 v[92:95], v[188:191], v[196:199], 0
ds_read_b64_tr_b16 v[204:205], v218 offset:4096
v_mfma_f32_16x16x32_bf16 v[44:47], v[192:195], v[188:191], 0
ds_read_b64_tr_b16 v[206:207], v218 offset:4608
ds_read_b64_tr_b16 v[208:209], v218 offset:12288
ds_read_b64_tr_b16 v[210:211], v218 offset:12800
ds_read_b64_tr_b16 v[212:213], v218 offset:20480
ds_read_b64_tr_b16 v[214:215], v218 offset:20992
ds_read_b128 v[152:155], v217 offset:4096
ds_read_b128 v[156:159], v217 offset:6144
ds_read_b128 v[160:163], v217 offset:8192
ds_read_b128 v[164:167], v217 offset:10240
ds_read_b128 v[168:171], v217 offset:12288
ds_read_b128 v[172:175], v217 offset:14336
ds_read_b128 v[176:179], v217 offset:16384
ds_read_b128 v[180:183], v217 offset:18432
ds_read_b128 v[184:187], v217 offset:20480
M_loop_qkv:
s_waitcnt lgkmcnt(2)
v_mfma_f32_16x16x32_bf16 v[0:3], v[204:207], v[144:147], v[0:3]
ds_read_b128 v[188:191], v217 offset:22528
v_mfma_f32_16x16x32_bf16 v[48:51], v[144:147], v[208:211], v[48:51]
v_add_u32 v216, s64, v216
v_mfma_f32_16x16x32_bf16 v[96:99], v[144:147], v[212:215], v[96:99]
v_add_u32 v217, s64, v217
v_mfma_f32_16x16x32_bf16 v[100:103], v[148:151], v[212:215], v[100:103]
v_add_u32 v218, s64, v218
v_mfma_f32_16x16x32_bf16 v[52:55], v[148:151], v[208:211], v[52:55]
v_mfma_f32_16x16x32_bf16 v[4:7], v[204:207], v[148:151], v[4:7]
v_mfma_f32_16x16x32_bf16 v[8:11], v[204:207], v[152:155], v[8:11]
v_mfma_f32_16x16x32_bf16 v[56:59], v[152:155], v[208:211], v[56:59]
v_mfma_f32_16x16x32_bf16 v[104:107], v[152:155], v[212:215], v[104:107]
v_mfma_f32_16x16x32_bf16 v[108:111], v[156:159], v[212:215], v[108:111]
s_waitcnt lgkmcnt(0)
s_barrier
v_mfma_f32_16x16x32_bf16 v[60:63], v[156:159], v[208:211], v[60:63]
ds_read_b128 v[144:147], v216 offset:0
v_mfma_f32_16x16x32_bf16 v[12:15], v[204:207], v[156:159], v[12:15]
ds_read_b128 v[148:151], v216 offset:2048
v_mfma_f32_16x16x32_bf16 v[16:19], v[204:207], v[160:163], v[16:19]
ds_read_b64_tr_b16 v[192:193], v218 offset:0
v_mfma_f32_16x16x32_bf16 v[64:67], v[160:163], v[208:211], v[64:67]
ds_read_b64_tr_b16 v[194:195], v218 offset:512
v_mfma_f32_16x16x32_bf16 v[112:115], v[160:163], v[212:215], v[112:115]
ds_read_b64_tr_b16 v[196:197], v218 offset:8192
v_mfma_f32_16x16x32_bf16 v[116:119], v[164:167], v[212:215], v[116:119]
ds_read_b64_tr_b16 v[198:199], v218 offset:8704
v_mfma_f32_16x16x32_bf16 v[68:71], v[164:167], v[208:211], v[68:71]
ds_read_b64_tr_b16 v[200:201], v218 offset:16384
v_mfma_f32_16x16x32_bf16 v[20:23], v[204:207], v[164:167], v[20:23]
ds_read_b64_tr_b16 v[202:203], v218 offset:16896
v_mfma_f32_16x16x32_bf16 v[24:27], v[204:207], v[168:171], v[24:27]
ds_read_b128 v[152:155], v216 offset:4096
v_mfma_f32_16x16x32_bf16 v[72:75], v[168:171], v[208:211], v[72:75]
ds_read_b128 v[156:159], v216 offset:6144
v_mfma_f32_16x16x32_bf16 v[120:123], v[168:171], v[212:215], v[120:123]
ds_read_b128 v[160:163], v216 offset:8192
v_mfma_f32_16x16x32_bf16 v[124:127], v[172:175], v[212:215], v[124:127]
ds_read_b128 v[164:167], v216 offset:10240
v_mfma_f32_16x16x32_bf16 v[76:79], v[172:175], v[208:211], v[76:79]
ds_read_b128 v[168:171], v216 offset:12288
v_mfma_f32_16x16x32_bf16 v[28:31], v[204:207], v[172:175], v[28:31]
v_mfma_f32_16x16x32_bf16 v[32:35], v[204:207], v[176:179], v[32:35]
ds_read_b128 v[172:175], v216 offset:14336
v_mfma_f32_16x16x32_bf16 v[80:83], v[176:179], v[208:211], v[80:83]
v_mfma_f32_16x16x32_bf16 v[128:131], v[176:179], v[212:215], v[128:131]
v_mfma_f32_16x16x32_bf16 v[132:135], v[180:183], v[212:215], v[132:135]
ds_read_b128 v[176:179], v216 offset:16384
v_mfma_f32_16x16x32_bf16 v[84:87], v[180:183], v[208:211], v[84:87]
v_mfma_f32_16x16x32_bf16 v[36:39], v[204:207], v[180:183], v[36:39]
v_mfma_f32_16x16x32_bf16 v[40:43], v[204:207], v[184:187], v[40:43]
ds_read_b128 v[180:183], v216 offset:18432
v_mfma_f32_16x16x32_bf16 v[88:91], v[184:187], v[208:211], v[88:91]
v_mfma_f32_16x16x32_bf16 v[136:139], v[184:187], v[212:215], v[136:139]
v_mfma_f32_16x16x32_bf16 v[140:143], v[188:191], v[212:215], v[140:143]
ds_read_b128 v[184:187], v216 offset:20480
v_mfma_f32_16x16x32_bf16 v[92:95], v[188:191], v[208:211], v[92:95]
v_mfma_f32_16x16x32_bf16 v[44:47], v[204:207], v[188:191], v[44:47]
M_in_qkv:
s_waitcnt lgkmcnt(2)
v_mfma_f32_16x16x32_bf16 v[0:3], v[192:195], v[144:147], v[0:3]
ds_read_b128 v[188:191], v216 offset:22528
v_mfma_f32_16x16x32_bf16 v[48:51], v[144:147], v[196:199], v[48:51]
s_cmp_eq_u32 s63, 98304
v_mfma_f32_16x16x32_bf16 v[96:99], v[144:147], v[200:203], v[96:99]
s_cselect_b32 s64, 4294868992, s65
v_mfma_f32_16x16x32_bf16 v[100:103], v[148:151], v[200:203], v[100:103]
s_add_u32 s63, s63, s64
v_mfma_f32_16x16x32_bf16 v[52:55], v[148:151], v[196:199], v[52:55]
s_add_u32 s66, s66, 1
v_mfma_f32_16x16x32_bf16 v[4:7], v[192:195], v[148:151], v[4:7]
s_cmp_lt_u32 s66, 8
v_mfma_f32_16x16x32_bf16 v[8:11], v[192:195], v[152:155], v[8:11]
v_mfma_f32_16x16x32_bf16 v[56:59], v[152:155], v[196:199], v[56:59]
v_mfma_f32_16x16x32_bf16 v[104:107], v[152:155], v[200:203], v[104:107]
v_mfma_f32_16x16x32_bf16 v[108:111], v[156:159], v[200:203], v[108:111]
s_waitcnt lgkmcnt(0)
v_mfma_f32_16x16x32_bf16 v[60:63], v[156:159], v[196:199], v[60:63]
ds_read_b128 v[144:147], v217 offset:0
v_mfma_f32_16x16x32_bf16 v[12:15], v[192:195], v[156:159], v[12:15]
ds_read_b128 v[148:151], v217 offset:2048
v_mfma_f32_16x16x32_bf16 v[16:19], v[192:195], v[160:163], v[16:19]
ds_read_b64_tr_b16 v[204:205], v218 offset:4096
v_mfma_f32_16x16x32_bf16 v[64:67], v[160:163], v[196:199], v[64:67]
ds_read_b64_tr_b16 v[206:207], v218 offset:4608
v_mfma_f32_16x16x32_bf16 v[112:115], v[160:163], v[200:203], v[112:115]
ds_read_b64_tr_b16 v[208:209], v218 offset:12288
v_mfma_f32_16x16x32_bf16 v[116:119], v[164:167], v[200:203], v[116:119]
ds_read_b64_tr_b16 v[210:211], v218 offset:12800
v_mfma_f32_16x16x32_bf16 v[68:71], v[164:167], v[196:199], v[68:71]
ds_read_b64_tr_b16 v[212:213], v218 offset:20480
v_mfma_f32_16x16x32_bf16 v[20:23], v[192:195], v[164:167], v[20:23]
ds_read_b64_tr_b16 v[214:215], v218 offset:20992
v_mfma_f32_16x16x32_bf16 v[24:27], v[192:195], v[168:171], v[24:27]
ds_read_b128 v[152:155], v217 offset:4096
v_mfma_f32_16x16x32_bf16 v[72:75], v[168:171], v[196:199], v[72:75]
ds_read_b128 v[156:159], v217 offset:6144
v_mfma_f32_16x16x32_bf16 v[120:123], v[168:171], v[200:203], v[120:123]
ds_read_b128 v[160:163], v217 offset:8192
v_mfma_f32_16x16x32_bf16 v[124:127], v[172:175], v[200:203], v[124:127]
ds_read_b128 v[164:167], v217 offset:10240
v_mfma_f32_16x16x32_bf16 v[76:79], v[172:175], v[196:199], v[76:79]
ds_read_b128 v[168:171], v217 offset:12288
v_mfma_f32_16x16x32_bf16 v[28:31], v[192:195], v[172:175], v[28:31]
v_mfma_f32_16x16x32_bf16 v[32:35], v[192:195], v[176:179], v[32:35]
ds_read_b128 v[172:175], v217 offset:14336
v_mfma_f32_16x16x32_bf16 v[80:83], v[176:179], v[196:199], v[80:83]
v_mfma_f32_16x16x32_bf16 v[128:131], v[176:179], v[200:203], v[128:131]
v_mfma_f32_16x16x32_bf16 v[132:135], v[180:183], v[200:203], v[132:135]
ds_read_b128 v[176:179], v217 offset:16384
v_mfma_f32_16x16x32_bf16 v[84:87], v[180:183], v[196:199], v[84:87]
v_mfma_f32_16x16x32_bf16 v[36:39], v[192:195], v[180:183], v[36:39]
v_mfma_f32_16x16x32_bf16 v[40:43], v[192:195], v[184:187], v[40:43]
ds_read_b128 v[180:183], v217 offset:18432
v_mfma_f32_16x16x32_bf16 v[88:91], v[184:187], v[196:199], v[88:91]
v_mfma_f32_16x16x32_bf16 v[136:139], v[184:187], v[200:203], v[136:139]
v_mfma_f32_16x16x32_bf16 v[140:143], v[188:191], v[200:203], v[140:143]
ds_read_b128 v[184:187], v217 offset:20480
v_mfma_f32_16x16x32_bf16 v[92:95], v[188:191], v[196:199], v[92:95]
v_mfma_f32_16x16x32_bf16 v[44:47], v[192:195], v[188:191], v[44:47]
s_cbranch_scc1 M_loop_qkv
WS_5:
s_cbranch_execz WS_9
s_waitcnt lgkmcnt(2)
v_mfma_f32_16x16x32_bf16 v[48:51], v[144:147], v[208:211], v[48:51]
ds_read_b128 v[188:191], v217 offset:22528
v_mfma_f32_16x16x32_bf16 v[96:99], v[144:147], v[212:215], v[96:99]
ds_read2_b32 v[224:225], v220 offset0:0 offset1:16
v_mfma_f32_16x16x32_bf16 v[100:103], v[148:151], v[212:215], v[100:103]
ds_read2_b32 v[226:227], v220 offset0:32 offset1:48
v_mfma_f32_16x16x32_bf16 v[52:55], v[148:151], v[208:211], v[52:55]
ds_read2_b32 v[228:229], v220 offset0:64 offset1:80
v_mfma_f32_16x16x32_bf16 v[56:59], v[152:155], v[208:211], v[56:59]
ds_read2_b32 v[230:231], v220 offset0:96 offset1:112
v_mfma_f32_16x16x32_bf16 v[104:107], v[152:155], v[212:215], v[104:107]
ds_read2_b32 v[232:233], v220 offset0:128 offset1:144
v_mfma_f32_16x16x32_bf16 v[108:111], v[156:159], v[212:215], v[108:111]
ds_read2_b32 v[234:235], v220 offset0:160 offset1:176
v_mfma_f32_16x16x32_bf16 v[60:63], v[156:159], v[208:211], v[60:63]
v_mfma_f32_16x16x32_bf16 v[64:67], v[160:163], v[208:211], v[64:67]
v_mfma_f32_16x16x32_bf16 v[112:115], v[160:163], v[212:215], v[112:115]
v_mfma_f32_16x16x32_bf16 v[116:119], v[164:167], v[212:215], v[116:119]
s_waitcnt lgkmcnt(0)
v_mfma_f32_16x16x32_bf16 v[68:71], v[164:167], v[208:211], v[68:71]
M_kend_qkv:
v_mfma_f32_16x16x32_bf16 v[72:75], v[168:171], v[208:211], v[72:75]
v_mul_f32 v192, s30, v48
v_mul_f32 v193, s30, v49
v_mfma_f32_16x16x32_bf16 v[120:123], v[168:171], v[212:215], v[120:123]
v_exp_f32 v192, v192 clamp
v_mfma_f32_16x16x32_bf16 v[124:127], v[172:175], v[212:215], v[124:127]
v_exp_f32 v193, v193 clamp
v_mfma_f32_16x16x32_bf16 v[76:79], v[172:175], v[208:211], v[76:79]
v_mul_f32 v194, s30, v50
v_mul_f32 v195, s30, v51
v_mfma_f32_16x16x32_bf16 v[80:83], v[176:179], v[208:211], v[80:83]
v_exp_f32 v194, v194 clamp
v_mfma_f32_16x16x32_bf16 v[128:131], v[176:179], v[212:215], v[128:131]
v_exp_f32 v195, v195 clamp
v_mfma_f32_16x16x32_bf16 v[132:135], v[180:183], v[212:215], v[132:135]
v_mul_f32 v196, s30, v52
v_mul_f32 v197, s30, v53
v_mfma_f32_16x16x32_bf16 v[84:87], v[180:183], v[208:211], v[84:87]
v_exp_f32 v196, v196 clamp
v_mfma_f32_16x16x32_bf16 v[88:91], v[184:187], v[208:211], v[88:91]
v_exp_f32 v197, v197 clamp
v_mfma_f32_16x16x32_bf16 v[136:139], v[184:187], v[212:215], v[136:139]
v_mul_f32 v198, s30, v54
v_mul_f32 v199, s30, v55
v_mfma_f32_16x16x32_bf16 v[140:143], v[188:191], v[212:215], v[140:143]
v_exp_f32 v198, v198 clamp
v_mfma_f32_16x16x32_bf16 v[92:95], v[188:191], v[208:211], v[92:95]
v_exp_f32 v199, v199 clamp
v_max_f32 v48, s3, v48
v_max_f32 v49, s3, v49
v_max_f32 v50, s3, v50
v_max_f32 v51, s3, v51
v_max_f32 v52, s3, v52
v_max_f32 v53, s3, v53
v_max_f32 v54, s3, v54
v_max_f32 v55, s3, v55
v_pk_add_f32 v[48:49], v[48:49], v[192:193]
v_pk_add_f32 v[50:51], v[50:51], v[194:195]
v_pk_add_f32 v[52:53], v[52:53], v[196:197]
v_pk_add_f32 v[54:55], v[54:55], v[198:199]
v_cvt_pk_bf16_f32 v48, v48, v49
v_cvt_pk_bf16_f32 v49, v50, v51
v_cvt_pk_bf16_f32 v50, v52, v53
v_cvt_pk_bf16_f32 v51, v54, v55
v_cvt_pk_bf16_f32 v96, v96, v97
v_cvt_pk_bf16_f32 v97, v98, v99
v_mfma_f32_16x16x32_bf16 v[216:219], v[48:51], v[236:239], 0
v_cvt_pk_bf16_f32 v98, v100, v101
v_cvt_pk_bf16_f32 v99, v102, v103
v_cvt_pk_bf16_f32 v104, v104, v105
v_cvt_pk_bf16_f32 v105, v106, v107
v_mfma_f32_16x16x32_bf16 v[200:203], v[48:51], v[96:99], 0
v_cvt_pk_bf16_f32 v106, v108, v109
v_cvt_pk_bf16_f32 v107, v110, v111
v_pk_mul_f32 v[208:209], v[56:57], s[30:31]
v_max_f32 v56, s3, v56
v_exp_f32 v208, v208 clamp
v_max_f32 v57, s3, v57
v_exp_f32 v209, v209 clamp
v_pk_mul_f32 v[210:211], v[58:59], s[30:31]
v_pk_mul_f32 v[212:213], v[60:61], s[30:31]
v_exp_f32 v210, v210 clamp
v_pk_mul_f32 v[214:215], v[62:63], s[30:31]
v_exp_f32 v211, v211 clamp
v_max_f32 v58, s3, v58
v_exp_f32 v212, v212 clamp
v_max_f32 v59, s3, v59
v_exp_f32 v213, v213 clamp
v_max_f32 v60, s3, v60
v_exp_f32 v214, v214 clamp
v_max_f32 v61, s3, v61
v_exp_f32 v215, v215 clamp
v_max_f32 v62, s3, v62
v_max_f32 v63, s3, v63
v_pk_add_f32 v[56:57], v[56:57], v[208:209]
v_pk_add_f32 v[58:59], v[58:59], v[210:211]
v_pk_add_f32 v[60:61], v[60:61], v[212:213]
v_pk_add_f32 v[62:63], v[62:63], v[214:215]
v_cvt_pk_bf16_f32 v56, v56, v57
v_cvt_pk_bf16_f32 v57, v58, v59
v_cvt_pk_bf16_f32 v58, v60, v61
v_cvt_pk_bf16_f32 v59, v62, v63
v_pk_mul_f32 v[192:193], v[64:65], s[30:31]
v_pk_mul_f32 v[194:195], v[66:67], s[30:31]
v_mfma_f32_16x16x32_bf16 v[200:203], v[56:59], v[104:107], v[200:203]
v_exp_f32 v192, v192 clamp
v_mfma_f32_16x16x32_bf16 v[216:219], v[56:59], v[236:239], v[216:219]
v_exp_f32 v193, v193 clamp
v_max_f32 v64, s3, v64
v_exp_f32 v194, v194 clamp
v_max_f32 v65, s3, v65
v_exp_f32 v195, v195 clamp
v_max_f32 v66, s3, v66
v_max_f32 v67, s3, v67
v_pk_mul_f32 v[196:197], v[68:69], s[30:31]
v_pk_mul_f32 v[198:199], v[70:71], s[30:31]
v_exp_f32 v196, v196 clamp
v_max_f32 v68, s3, v68
v_exp_f32 v197, v197 clamp
v_max_f32 v69, s3, v69
v_exp_f32 v198, v198 clamp
v_max_f32 v70, s3, v70
v_exp_f32 v199, v199 clamp
WS_6:
s_cbranch_execz WS_10
v_max_f32 v71, s3, v71
v_pk_add_f32 v[64:65], v[64:65], v[192:193]
v_pk_add_f32 v[66:67], v[66:67], v[194:195]
v_pk_add_f32 v[68:69], v[68:69], v[196:197]
v_pk_add_f32 v[70:71], v[70:71], v[198:199]
v_cvt_pk_bf16_f32 v64, v64, v65
v_cvt_pk_bf16_f32 v65, v66, v67
v_cvt_pk_bf16_f32 v66, v68, v69
v_cvt_pk_bf16_f32 v67, v70, v71
v_cvt_pk_bf16_f32 v112, v112, v113
v_cvt_pk_bf16_f32 v113, v114, v115
v_mfma_f32_16x16x32_bf16 v[216:219], v[64:67], v[236:239], v[216:219]
v_cvt_pk_bf16_f32 v114, v116, v117
v_cvt_pk_bf16_f32 v115, v118, v119
v_cvt_pk_bf16_f32 v120, v120, v121
v_cvt_pk_bf16_f32 v121, v122, v123
v_mfma_f32_16x16x32_bf16 v[200:203], v[64:67], v[112:115], v[200:203]
v_cvt_pk_bf16_f32 v122, v124, v125
v_cvt_pk_bf16_f32 v123, v126, v127
v_pk_mul_f32 v[208:209], v[72:73], s[30:31]
v_max_f32 v72, s3, v72
v_exp_f32 v208, v208 clamp
v_max_f32 v73, s3, v73
v_exp_f32 v209, v209 clamp
v_pk_mul_f32 v[210:211], v[74:75], s[30:31]
v_pk_mul_f32 v[212:213], v[76:77], s[30:31]
v_exp_f32 v210, v210 clamp
v_pk_mul_f32 v[214:215], v[78:79], s[30:31]
v_exp_f32 v211, v211 clamp
v_max_f32 v74, s3, v74
v_exp_f32 v212, v212 clamp
v_max_f32 v75, s3, v75
v_exp_f32 v213, v213 clamp
v_max_f32 v76, s3, v76
v_exp_f32 v214, v214 clamp
v_max_f32 v77, s3, v77
v_exp_f32 v215, v215 clamp
v_max_f32 v78, s3, v78
v_max_f32 v79, s3, v79
v_pk_add_f32 v[72:73], v[72:73], v[208:209]
v_pk_add_f32 v[74:75], v[74:75], v[210:211]
v_pk_add_f32 v[76:77], v[76:77], v[212:213]
v_pk_add_f32 v[78:79], v[78:79], v[214:215]
v_cvt_pk_bf16_f32 v72, v72, v73
v_cvt_pk_bf16_f32 v73, v74, v75
v_cvt_pk_bf16_f32 v74, v76, v77
v_cvt_pk_bf16_f32 v75, v78, v79
v_pk_mul_f32 v[192:193], v[80:81], s[30:31]
v_pk_mul_f32 v[194:195], v[82:83], s[30:31]
v_mfma_f32_16x16x32_bf16 v[200:203], v[72:75], v[120:123], v[200:203]
v_exp_f32 v192, v192 clamp
v_mfma_f32_16x16x32_bf16 v[216:219], v[72:75], v[236:239], v[216:219]
v_exp_f32 v193, v193 clamp
v_max_f32 v80, s3, v80
v_exp_f32 v194, v194 clamp
v_max_f32 v81, s3, v81
v_exp_f32 v195, v195 clamp
v_max_f32 v82, s3, v82
v_max_f32 v83, s3, v83
v_pk_mul_f32 v[196:197], v[84:85], s[30:31]
v_pk_mul_f32 v[198:199], v[86:87], s[30:31]
v_exp_f32 v196, v196 clamp
v_max_f32 v84, s3, v84
v_exp_f32 v197, v197 clamp
v_max_f32 v85, s3, v85
v_exp_f32 v198, v198 clamp
v_max_f32 v86, s3, v86
v_exp_f32 v199, v199 clamp
v_max_f32 v87, s3, v87
v_pk_add_f32 v[80:81], v[80:81], v[192:193]
v_pk_add_f32 v[82:83], v[82:83], v[194:195]
v_pk_add_f32 v[84:85], v[84:85], v[196:197]
v_pk_add_f32 v[86:87], v[86:87], v[198:199]
v_cvt_pk_bf16_f32 v80, v80, v81
v_cvt_pk_bf16_f32 v81, v82, v83
v_cvt_pk_bf16_f32 v82, v84, v85
v_cvt_pk_bf16_f32 v83, v86, v87
v_mov_b32 v236, s75
v_mov_b32 v237, s75
v_mov_b32 v238, s75
v_mov_b32 v239, s75
v_cvt_pk_bf16_f32 v128, v128, v129
v_cvt_pk_bf16_f32 v129, v130, v131
v_mfma_f32_16x16x32_bf16 v[216:219], v[80:83], v[236:239], v[216:219]
v_cvt_pk_bf16_f32 v130, v132, v133
v_cvt_pk_bf16_f32 v131, v134, v135
v_cvt_pk_bf16_f32 v136, v136, v137
v_cvt_pk_bf16_f32 v137, v138, v139
v_mfma_f32_16x16x32_bf16 v[200:203], v[80:83], v[128:131], v[200:203]
v_cvt_pk_bf16_f32 v138, v140, v141
v_cvt_pk_bf16_f32 v139, v142, v143
v_pk_mul_f32 v[208:209], v[88:89], s[30:31]
v_max_f32 v88, s3, v88
v_exp_f32 v208, v208 clamp
v_max_f32 v89, s3, v89
v_exp_f32 v209, v209 clamp
v_pk_mul_f32 v[210:211], v[90:91], s[30:31]
v_pk_mul_f32 v[212:213], v[92:93], s[30:31]
v_exp_f32 v210, v210 clamp
v_pk_mul_f32 v[214:215], v[94:95], s[30:31]
v_exp_f32 v211, v211 clamp
v_max_f32 v90, s3, v90
v_exp_f32 v212, v212 clamp
v_max_f32 v91, s3, v91
v_exp_f32 v213, v213 clamp
v_max_f32 v92, s3, v92
v_exp_f32 v214, v214 clamp
v_max_f32 v93, s3, v93
v_exp_f32 v215, v215 clamp
v_max_f32 v94, s3, v94
v_max_f32 v95, s3, v95
v_pk_add_f32 v[88:89], v[88:89], v[208:209]
v_pk_add_f32 v[90:91], v[90:91], v[210:211]
v_pk_add_f32 v[92:93], v[92:93], v[212:213]
v_pk_add_f32 v[94:95], v[94:95], v[214:215]
v_cvt_pk_bf16_f32 v88, v88, v89
v_cvt_pk_bf16_f32 v89, v90, v91
v_cvt_pk_bf16_f32 v90, v92, v93
v_cvt_pk_bf16_f32 v91, v94, v95
s_nop 0
s_nop 0
v_mfma_f32_16x16x32_bf16 v[200:203], v[88:91], v[136:139], v[200:203]
v_mfma_f32_16x16x32_bf16 v[216:219], v[88:91], v[236:239], v[216:219]
v_mfma_f32_16x16x32_bf16 v[0:3], v[204:207], v[144:147], v[0:3]
v_mfma_f32_16x16x32_bf16 v[4:7], v[204:207], v[148:151], v[4:7]
s_nop 4
v_and_or_b32 v200, v200, v223, s32
v_and_or_b32 v201, v201, v223, s33
v_and_or_b32 v202, v202, v223, s34
v_and_or_b32 v203, v203, v223, s35
buffer_store_dwordx4 v[200:203], v251, s[44:47], s73 offen sc1
v_and_or_b32 v216, v216, v223, s32
v_and_or_b32 v217, v217, v223, s33
v_and_or_b32 v218, v218, v223, s34
v_and_or_b32 v219, v219, v223, s35
s_mov_b32 exec_lo, 65537
s_mov_b32 exec_hi, 65537
buffer_store_dwordx4 v[216:219], v221, s[44:47], s73 offen offset:1024 sc1
s_mov_b64 exec, -1
s_mov_b32 s67, 0
v_mfma_f32_16x16x32_bf16 v[8:11], v[204:207], v[152:155], v[8:11]
v_mfma_f32_16x16x32_bf16 v[12:15], v[204:207], v[156:159], v[12:15]
v_mfma_f32_16x16x32_bf16 v[16:19], v[204:207], v[160:163], v[16:19]
v_mfma_f32_16x16x32_bf16 v[20:23], v[204:207], v[164:167], v[20:23]
v_mfma_f32_16x16x32_bf16 v[24:27], v[204:207], v[168:171], v[24:27]
v_mfma_f32_16x16x32_bf16 v[28:31], v[204:207], v[172:175], v[28:31]
v_mfma_f32_16x16x32_bf16 v[32:35], v[204:207], v[176:179], v[32:35]
v_mfma_f32_16x16x32_bf16 v[36:39], v[204:207], v[180:183], v[36:39]
v_mfma_f32_16x16x32_bf16 v[40:43], v[204:207], v[184:187], v[40:43]
v_mfma_f32_16x16x32_bf16 v[44:47], v[204:207], v[188:191], v[44:47]
v_pk_mul_f32 v[192:193], v[0:1], s[30:31]
v_max_f32 v0, s3, v0
v_exp_f32 v192, v192 clamp
v_max_f32 v1, s3, v1
v_exp_f32 v193, v193 clamp
v_pk_mul_f32 v[194:195], v[2:3], s[30:31]
v_max_f32 v2, s3, v2
v_exp_f32 v194, v194 clamp
v_pk_mul_f32 v[196:197], v[4:5], s[30:31]
v_exp_f32 v195, v195 clamp
v_pk_mul_f32 v[198:199], v[6:7], s[30:31]
v_exp_f32 v196, v196 clamp
v_max_f32 v3, s3, v3
v_exp_f32 v197, v197 clamp
v_max_f32 v4, s3, v4
v_exp_f32 v198, v198 clamp
v_max_f32 v5, s3, v5
v_exp_f32 v199, v199 clamp
v_max_f32 v6, s3, v6
v_max_f32 v7, s3, v7
v_pk_add_f32 v[0:1], v[0:1], v[192:193]
v_pk_add_f32 v[2:3], v[2:3], v[194:195]
v_pk_add_f32 v[4:5], v[4:5], v[196:197]
v_pk_add_f32 v[6:7], v[6:7], v[198:199]
v_cvt_pk_bf16_f32 v0, v0, v1
v_cvt_pk_bf16_f32 v1, v2, v3
v_cvt_pk_bf16_f32 v2, v4, v5
v_cvt_pk_bf16_f32 v3, v6, v7
s_barrier
v_pk_mul_f32 v[208:209], v[8:9], s[30:31]
v_max_f32 v8, s3, v8
v_exp_f32 v208, v208 clamp
v_max_f32 v9, s3, v9
v_exp_f32 v209, v209 clamp
v_pk_mul_f32 v[210:211], v[10:11], s[30:31]
v_pk_mul_f32 v[212:213], v[12:13], s[30:31]
v_exp_f32 v210, v210 clamp
v_pk_mul_f32 v[214:215], v[14:15], s[30:31]
v_exp_f32 v211, v211 clamp
v_max_f32 v10, s3, v10
v_exp_f32 v212, v212 clamp
v_max_f32 v11, s3, v11
v_exp_f32 v213, v213 clamp
v_max_f32 v12, s3, v12
v_exp_f32 v214, v214 clamp
v_max_f32 v13, s3, v13
v_exp_f32 v215, v215 clamp
v_max_f32 v14, s3, v14
v_max_f32 v15, s3, v15
v_pk_add_f32 v[8:9], v[8:9], v[208:209]
v_pk_add_f32 v[10:11], v[10:11], v[210:211]
v_pk_add_f32 v[12:13], v[12:13], v[212:213]
v_pk_add_f32 v[14:15], v[14:15], v[214:215]
v_cvt_pk_bf16_f32 v4, v8, v9
v_cvt_pk_bf16_f32 v5, v10, v11
v_cvt_pk_bf16_f32 v6, v12, v13
v_cvt_pk_bf16_f32 v7, v14, v15
v_pk_mul_f32 v[192:193], v[16:17], s[30:31]
v_pk_mul_f32 v[194:195], v[18:19], s[30:31]
v_exp_f32 v192, v192 clamp
v_pk_mul_f32 v[196:197], v[20:21], s[30:31]
v_exp_f32 v193, v193 clamp
v_pk_mul_f32 v[198:199], v[22:23], s[30:31]
v_exp_f32 v194, v194 clamp
v_max_f32 v16, s3, v16
v_exp_f32 v195, v195 clamp
v_max_f32 v17, s3, v17
v_exp_f32 v196, v196 clamp
v_max_f32 v18, s3, v18
v_exp_f32 v197, v197 clamp
v_max_f32 v19, s3, v19
v_exp_f32 v198, v198 clamp
v_max_f32 v20, s3, v20
v_exp_f32 v199, v199 clamp
v_max_f32 v21, s3, v21
v_max_f32 v22, s3, v22
v_max_f32 v23, s3, v23
v_pk_add_f32 v[16:17], v[16:17], v[192:193]
v_pk_add_f32 v[18:19], v[18:19], v[194:195]
v_pk_add_f32 v[20:21], v[20:21], v[196:197]
v_pk_add_f32 v[22:23], v[22:23], v[198:199]
v_cvt_pk_bf16_f32 v8, v16, v17
v_cvt_pk_bf16_f32 v9, v18, v19
v_cvt_pk_bf16_f32 v10, v20, v21
v_cvt_pk_bf16_f32 v11, v22, v23
v_mov_b32 v72, s32
v_mov_b32 v73, s33
v_mov_b32 v74, s34
v_mov_b32 v75, s35
s_add_u32 s67, s67, 1
s_cmp_lt_u32 s67, 524288
s_cselect_b32 s62, 255, 0
s_mov_b32 exec_lo, 0x7ff07ff
s_mov_b32 exec_hi, 0x7ff07ff
buffer_load_dwordx4 v[72:75], v222, s[44:47], s72 offen offset:1024 sc1
s_mov_b64 exec, -1
v_pk_mul_f32 v[208:209], v[24:25], s[30:31]
v_max_f32 v24, s3, v24
v_exp_f32 v208, v208 clamp
v_max_f32 v25, s3, v25
v_exp_f32 v209, v209 clamp
v_pk_mul_f32 v[210:211], v[26:27], s[30:31]
v_pk_mul_f32 v[212:213], v[28:29], s[30:31]
v_exp_f32 v210, v210 clamp
v_pk_mul_f32 v[214:215], v[30:31], s[30:31]
v_exp_f32 v211, v211 clamp
v_max_f32 v26, s3, v26
v_exp_f32 v212, v212 clamp
v_max_f32 v27, s3, v27
v_exp_f32 v213, v213 clamp
v_max_f32 v28, s3, v28
v_exp_f32 v214, v214 clamp
v_max_f32 v29, s3, v29
v_exp_f32 v215, v215 clamp
v_max_f32 v30, s3, v30
v_max_f32 v31, s3, v31
v_pk_add_f32 v[24:25], v[24:25], v[208:209]
v_pk_add_f32 v[26:27], v[26:27], v[210:211]
v_pk_add_f32 v[28:29], v[28:29], v[212:213]
v_pk_add_f32 v[30:31], v[30:31], v[214:215]
v_cvt_pk_bf16_f32 v12, v24, v25
v_cvt_pk_bf16_f32 v13, v26, v27
v_cvt_pk_bf16_f32 v14, v28, v29
v_cvt_pk_bf16_f32 v15, v30, v31
v_pk_mul_f32 v[192:193], v[32:33], s[30:31]
v_pk_mul_f32 v[194:195], v[34:35], s[30:31]
v_exp_f32 v192, v192 clamp
v_pk_mul_f32 v[196:197], v[36:37], s[30:31]
v_exp_f32 v193, v193 clamp
v_pk_mul_f32 v[198:199], v[38:39], s[30:31]
v_exp_f32 v194, v194 clamp
v_max_f32 v32, s3, v32
v_exp_f32 v195, v195 clamp
v_max_f32 v33, s3, v33
v_exp_f32 v196, v196 clamp
v_max_f32 v34, s3, v34
v_exp_f32 v197, v197 clamp
v_max_f32 v35, s3, v35
v_exp_f32 v198, v198 clamp
v_max_f32 v36, s3, v36
v_exp_f32 v199, v199 clamp
v_max_f32 v37, s3, v37
v_max_f32 v38, s3, v38
v_max_f32 v39, s3, v39
v_pk_add_f32 v[32:33], v[32:33], v[192:193]
v_pk_add_f32 v[34:35], v[34:35], v[194:195]
WS_7:
s_cbranch_execz WRET
v_pk_add_f32 v[36:37], v[36:37], v[196:197]
v_pk_add_f32 v[38:39], v[38:39], v[198:199]
v_cvt_pk_bf16_f32 v16, v32, v33
v_cvt_pk_bf16_f32 v17, v34, v35
v_cvt_pk_bf16_f32 v18, v36, v37
v_cvt_pk_bf16_f32 v19, v38, v39
v_pk_mul_f32 v[208:209], v[40:41], s[30:31]
v_pk_mul_f32 v[210:211], v[42:43], s[30:31]
v_exp_f32 v208, v208 clamp
v_pk_mul_f32 v[212:213], v[44:45], s[30:31]
v_exp_f32 v209, v209 clamp
v_pk_mul_f32 v[214:215], v[46:47], s[30:31]
v_exp_f32 v210, v210 clamp
v_max_f32 v40, s3, v40
v_exp_f32 v211, v211 clamp
v_max_f32 v41, s3, v41
v_exp_f32 v212, v212 clamp
v_max_f32 v42, s3, v42
v_exp_f32 v213, v213 clamp
v_max_f32 v43, s3, v43
v_exp_f32 v214, v214 clamp
v_max_f32 v44, s3, v44
v_exp_f32 v215, v215 clamp
v_max_f32 v45, s3, v45
v_max_f32 v46, s3, v46
v_max_f32 v47, s3, v47
v_pk_add_f32 v[40:41], v[40:41], v[208:209]
v_pk_add_f32 v[42:43], v[42:43], v[210:211]
v_pk_add_f32 v[44:45], v[44:45], v[212:213]
v_pk_add_f32 v[46:47], v[46:47], v[214:215]
v_cvt_pk_bf16_f32 v20, v40, v41
v_cvt_pk_bf16_f32 v21, v42, v43
v_cvt_pk_bf16_f32 v22, v44, v45
v_cvt_pk_bf16_f32 v23, v46, v47
s_waitcnt vmcnt(0)
v_xor_b32 v72, s32, v72
v_xor_b32 v73, s33, v73
v_xor_b32 v74, s34, v74
v_xor_b32 v75, s35, v75
v_or3_b32 v76, v72, v73, v74
v_or_b32 v76, v76, v75
v_and_b32 v76, s62, v76
v_cmp_ne_u32 vcc, 0, v76
s_nop 0
s_cbranch_vccnz M_g1
buffer_load_dwordx4 v[24:27], v251, s[44:47], s72 offen offset:0 sc1
buffer_load_dwordx4 v[28:31], v251, s[44:47], s72 offen offset:1152 sc1
buffer_load_dwordx4 v[32:35], v251, s[44:47], s72 offen offset:2304 sc1
buffer_load_dwordx4 v[36:39], v251, s[44:47], s72 offen offset:3456 sc1
buffer_load_dwordx4 v[40:43], v251, s[44:47], s57 offen offset:0 sc1
buffer_load_dwordx4 v[44:47], v251, s[44:47], s57 offen offset:1152 sc1
buffer_load_dwordx4 v[48:51], v251, s[44:47], s57 offen offset:2304 sc1
buffer_load_dwordx4 v[52:55], v251, s[44:47], s57 offen offset:3456 sc1
buffer_load_dwordx4 v[56:59], v251, s[44:47], s58 offen offset:0 sc1
buffer_load_dwordx4 v[60:63], v251, s[44:47], s58 offen offset:1152 sc1
buffer_load_dwordx4 v[64:67], v251, s[44:47], s58 offen offset:2304 sc1
s_mov_b64 exec, 1
ds_add_u32 v240, v241
s_mov_b64 exec, -1
ds_read_b64_tr_b16 v[80:81], v244 offset:0
ds_read_b64_tr_b16 v[82:83], v244 offset:512
ds_read_b64_tr_b16 v[84:85], v245 offset:0
ds_read_b64_tr_b16 v[86:87], v245 offset:512
ds_read_b64_tr_b16 v[88:89], v246 offset:0
ds_read_b64_tr_b16 v[90:91], v246 offset:512
ds_read_b64_tr_b16 v[92:93], v247 offset:0
ds_read_b64_tr_b16 v[94:95], v247 offset:512
ds_read_b64_tr_b16 v[96:97], v244 offset:8192
ds_read_b64_tr_b16 v[98:99], v244 offset:8704
ds_read_b64_tr_b16 v[100:101], v245 offset:8192
ds_read_b64_tr_b16 v[102:103], v245 offset:8704
ds_read_b64_tr_b16 v[104:105], v246 offset:8192
ds_read_b64_tr_b16 v[106:107], v246 offset:8704
ds_read_b64_tr_b16 v[108:109], v247 offset:8192
ds_read_b64_tr_b16 v[110:111], v247 offset:8704
ds_read_b64_tr_b16 v[112:113], v244 offset:16384
ds_read_b64_tr_b16 v[114:115], v244 offset:16896
ds_read_b64_tr_b16 v[116:117], v245 offset:16384
ds_read_b64_tr_b16 v[118:119], v245 offset:16896
ds_read_b64_tr_b16 v[120:121], v246 offset:16384
ds_read_b64_tr_b16 v[122:123], v246 offset:16896
ds_read_b64_tr_b16 v[124:125], v247 offset:16384
ds_read_b64_tr_b16 v[126:127], v247 offset:16896
ds_read_b64_tr_b16 v[128:129], v244 offset:24576
ds_read_b64_tr_b16 v[130:131], v244 offset:25088
ds_read_b64_tr_b16 v[132:133], v245 offset:24576
ds_read_b64_tr_b16 v[134:135], v245 offset:25088
ds_read_b64_tr_b16 v[136:137], v246 offset:24576
ds_read_b64_tr_b16 v[138:139], v246 offset:25088
ds_read_b64_tr_b16 v[140:141], v247 offset:24576
ds_read_b64_tr_b16 v[142:143], v247 offset:25088
ds_read_b64_tr_b16 v[144:145], v244 offset:32768
ds_read_b64_tr_b16 v[146:147], v244 offset:33280
ds_read_b64_tr_b16 v[148:149], v245 offset:32768
ds_read_b64_tr_b16 v[150:151], v245 offset:33280
ds_read_b64_tr_b16 v[152:153], v246 offset:32768
ds_read_b64_tr_b16 v[154:155], v246 offset:33280
ds_read_b64_tr_b16 v[156:157], v247 offset:32768
ds_read_b64_tr_b16 v[158:159], v247 offset:33280
ds_read_b64_tr_b16 v[160:161], v244 offset:40960
ds_read_b64_tr_b16 v[162:163], v244 offset:41472
ds_read_b64_tr_b16 v[164:165], v245 offset:40960
ds_read_b64_tr_b16 v[166:167], v245 offset:41472
ds_read_b64_tr_b16 v[168:169], v246 offset:40960
ds_read_b64_tr_b16 v[170:171], v246 offset:41472
ds_read_b64_tr_b16 v[172:173], v247 offset:40960
ds_read_b64_tr_b16 v[174:175], v247 offset:41472
ds_read_b64_tr_b16 v[176:177], v244 offset:49152
ds_read_b64_tr_b16 v[178:179], v244 offset:49664
ds_read_b64_tr_b16 v[180:181], v245 offset:49152
ds_read_b64_tr_b16 v[182:183], v245 offset:49664
ds_read_b64_tr_b16 v[184:185], v246 offset:49152
ds_read_b64_tr_b16 v[186:187], v246 offset:49664
ds_read_b64_tr_b16 v[188:189], v247 offset:49152
ds_read_b64_tr_b16 v[190:191], v247 offset:49664
s_branch M_g3
M_g1:
v_mov_b32 v72, s32
v_mov_b32 v73, s33
v_mov_b32 v74, s34
v_mov_b32 v75, s35
s_add_u32 s67, s67, 1
s_cmp_lt_u32 s67, 524288
s_cselect_b32 s62, 255, 0
s_mov_b32 exec_lo, 0x7ff07ff
s_mov_b32 exec_hi, 0x7ff07ff
buffer_load_dwordx4 v[72:75], v222, s[44:47], s72 offen offset:1024 sc1
s_mov_b64 exec, -1
ds_read_b64_tr_b16 v[80:81], v244 offset:0
ds_read_b64_tr_b16 v[82:83], v244 offset:512
ds_read_b64_tr_b16 v[84:85], v245 offset:0
ds_read_b64_tr_b16 v[86:87], v245 offset:512
ds_read_b64_tr_b16 v[88:89], v246 offset:0
ds_read_b64_tr_b16 v[90:91], v246 offset:512
ds_read_b64_tr_b16 v[92:93], v247 offset:0
ds_read_b64_tr_b16 v[94:95], v247 offset:512
ds_read_b64_tr_b16 v[96:97], v244 offset:8192
ds_read_b64_tr_b16 v[98:99], v244 offset:8704
ds_read_b64_tr_b16 v[100:101], v245 offset:8192
ds_read_b64_tr_b16 v[102:103], v245 offset:8704
ds_read_b64_tr_b16 v[104:105], v246 offset:8192
ds_read_b64_tr_b16 v[106:107], v246 offset:8704
ds_read_b64_tr_b16 v[108:109], v247 offset:8192
ds_read_b64_tr_b16 v[110:111], v247 offset:8704
ds_read_b64_tr_b16 v[112:113], v244 offset:16384
ds_read_b64_tr_b16 v[114:115], v244 offset:16896
ds_read_b64_tr_b16 v[116:117], v245 offset:16384
ds_read_b64_tr_b16 v[118:119], v245 offset:16896
ds_read_b64_tr_b16 v[120:121], v246 offset:16384
ds_read_b64_tr_b16 v[122:123], v246 offset:16896
ds_read_b64_tr_b16 v[124:125], v247 offset:16384
ds_read_b64_tr_b16 v[126:127], v247 offset:16896
ds_read_b64_tr_b16 v[128:129], v244 offset:24576
ds_read_b64_tr_b16 v[130:131], v244 offset:25088
ds_read_b64_tr_b16 v[132:133], v245 offset:24576
ds_read_b64_tr_b16 v[134:135], v245 offset:25088
ds_read_b64_tr_b16 v[136:137], v246 offset:24576
ds_read_b64_tr_b16 v[138:139], v246 offset:25088
ds_read_b64_tr_b16 v[140:141], v247 offset:24576
ds_read_b64_tr_b16 v[142:143], v247 offset:25088
ds_read_b64_tr_b16 v[144:145], v244 offset:32768
ds_read_b64_tr_b16 v[146:147], v244 offset:33280
ds_read_b64_tr_b16 v[148:149], v245 offset:32768
ds_read_b64_tr_b16 v[150:151], v245 offset:33280
ds_read_b64_tr_b16 v[152:153], v246 offset:32768
ds_read_b64_tr_b16 v[154:155], v246 offset:33280
ds_read_b64_tr_b16 v[156:157], v247 offset:32768
ds_read_b64_tr_b16 v[158:159], v247 offset:33280
ds_read_b64_tr_b16 v[160:161], v244 offset:40960
ds_read_b64_tr_b16 v[162:163], v244 offset:41472
ds_read_b64_tr_b16 v[164:165], v245 offset:40960
ds_read_b64_tr_b16 v[166:167], v245 offset:41472
ds_read_b64_tr_b16 v[168:169], v246 offset:40960
ds_read_b64_tr_b16 v[170:171], v246 offset:41472
ds_read_b64_tr_b16 v[172:173], v247 offset:40960
ds_read_b64_tr_b16 v[174:175], v247 offset:41472
ds_read_b64_tr_b16 v[176:177], v244 offset:49152
ds_read_b64_tr_b16 v[178:179], v244 offset:49664
ds_read_b64_tr_b16 v[180:181], v245 offset:49152
ds_read_b64_tr_b16 v[182:183], v245 offset:49664
ds_read_b64_tr_b16 v[184:185], v246 offset:49152
ds_read_b64_tr_b16 v[186:187], v246 offset:49664
ds_read_b64_tr_b16 v[188:189], v247 offset:49152
ds_read_b64_tr_b16 v[190:191], v247 offset:49664
s_branch M_g2
M_gw:
v_mov_b32 v72, s32
v_mov_b32 v73, s33
v_mov_b32 v74, s34
v_mov_b32 v75, s35
s_add_u32 s67, s67, 1
s_cmp_lt_u32 s67, 524288
s_cselect_b32 s62, 255, 0
s_mov_b32 exec_lo, 0x7ff07ff
s_mov_b32 exec_hi, 0x7ff07ff
buffer_load_dwordx4 v[72:75], v222, s[44:47], s72 offen offset:1024 sc1
s_mov_b64 exec, -1
M_g2:
s_waitcnt vmcnt(0)
v_xor_b32 v72, s32, v72
v_xor_b32 v73, s33, v73
v_xor_b32 v74, s34, v74
v_xor_b32 v75, s35, v75
v_or3_b32 v76, v72, v73, v74
v_or_b32 v76, v76, v75
v_and_b32 v76, s62, v76
v_cmp_ne_u32 vcc, 0, v76
s_nop 0
s_cbranch_vccnz M_gw
buffer_load_dwordx4 v[24:27], v251, s[44:47], s72 offen offset:0 sc1
buffer_load_dwordx4 v[28:31], v251, s[44:47], s72 offen offset:1152 sc1
buffer_load_dwordx4 v[32:35], v251, s[44:47], s72 offen offset:2304 sc1
buffer_load_dwordx4 v[36:39], v251, s[44:47], s72 offen offset:3456 sc1
buffer_load_dwordx4 v[40:43], v251, s[44:47], s57 offen offset:0 sc1
buffer_load_dwordx4 v[44:47], v251, s[44:47], s57 offen offset:1152 sc1
buffer_load_dwordx4 v[48:51], v251, s[44:47], s57 offen offset:2304 sc1
buffer_load_dwordx4 v[52:55], v251, s[44:47], s57 offen offset:3456 sc1
buffer_load_dwordx4 v[56:59], v251, s[44:47], s58 offen offset:0 sc1
buffer_load_dwordx4 v[60:63], v251, s[44:47], s58 offen offset:1152 sc1
buffer_load_dwordx4 v[64:67], v251, s[44:47], s58 offen offset:2304 sc1
s_mov_b64 exec, 1
ds_add_u32 v240, v241
s_mov_b64 exec, -1
M_g3:
s_mov_b32 vcc_lo, 0x55555555
s_mov_b32 vcc_hi, 0x55555555
v_add_f32_dpp v72, v72, v72 quad_perm:[1,0,3,2] row_mask:0xf bank_mask:0xf
v_add_f32_dpp v73, v73, v73 quad_perm:[1,0,3,2] row_mask:0xf bank_mask:0xf
v_add_f32_dpp v74, v74, v74 quad_perm:[1,0,3,2] row_mask:0xf bank_mask:0xf
v_add_f32_dpp v75, v75, v75 quad_perm:[1,0,3,2] row_mask:0xf bank_mask:0xf
v_add_f32_dpp v72, v72, v72 quad_perm:[2,3,0,1] row_mask:0xf bank_mask:0xf
v_add_f32_dpp v73, v73, v73 quad_perm:[2,3,0,1] row_mask:0xf bank_mask:0xf
v_add_f32_dpp v74, v74, v74 quad_perm:[2,3,0,1] row_mask:0xf bank_mask:0xf
v_add_f32_dpp v75, v75, v75 quad_perm:[2,3,0,1] row_mask:0xf bank_mask:0xf
v_add_f32_dpp v72, v72, v72 row_half_mirror row_mask:0xf bank_mask:0xf
v_add_f32_dpp v73, v73, v73 row_half_mirror row_mask:0xf bank_mask:0xf
v_add_f32_dpp v74, v74, v74 row_half_mirror row_mask:0xf bank_mask:0xf
v_add_f32_dpp v75, v75, v75 row_half_mirror row_mask:0xf bank_mask:0xf
v_add_f32_dpp v72, v72, v72 row_mirror row_mask:0xf bank_mask:0xf
v_add_f32_dpp v73, v73, v73 row_mirror row_mask:0xf bank_mask:0xf
v_add_f32_dpp v74, v74, v74 row_mirror row_mask:0xf bank_mask:0xf
v_add_f32_dpp v75, v75, v75 row_mirror row_mask:0xf bank_mask:0xf
v_cvt_pk_bf16_f32 v72, v72, v73
v_cvt_pk_bf16_f32 v73, v74, v75
v_cndmask_b32 v216, 0, v72, vcc
v_cndmask_b32 v217, 0, v73, vcc
v_xor_b32 v218, v216, v72
v_xor_b32 v219, v217, v73
s_mov_b32 s60, s3
s_mov_b32 s61, s3
s_waitcnt vmcnt(8)
v_mfma_f32_16x16x32_bf16 v[192:195], v[216:219], v[0:3], 0
v_xor_b32 v24, s32, v24
v_xor_b32 v25, s33, v25
v_mfma_f32_16x16x32_bf16 v[196:199], v[216:219], v[4:7], 0
v_xor_b32 v26, s34, v26
v_xor_b32 v27, s35, v27
v_mfma_f32_16x16x32_bf16 v[200:203], v[216:219], v[8:11], 0
v_or3_b32 v76, v24, v25, v76
v_xor_b32 v28, s32, v28
v_mfma_f32_16x16x32_bf16 v[204:207], v[216:219], v[12:15], 0
v_or3_b32 v76, v26, v27, v76
v_xor_b32 v29, s33, v29
v_mfma_f32_16x16x32_bf16 v[208:211], v[216:219], v[16:19], 0
v_xor_b32 v30, s34, v30
v_xor_b32 v31, s35, v31
v_mfma_f32_16x16x32_bf16 v[212:215], v[216:219], v[20:23], 0
v_or3_b32 v76, v28, v29, v76
v_xor_b32 v32, s32, v32
v_or3_b32 v76, v30, v31, v76
v_xor_b32 v33, s33, v33
v_xor_b32 v34, s34, v34
v_xor_b32 v35, s35, v35
v_or3_b32 v76, v32, v33, v76
v_or3_b32 v76, v34, v35, v76
v_pk_add_f32 v[24:25], v[24:25], v[28:29]
v_pk_add_f32 v[26:27], v[26:27], v[30:31]
v_pk_add_f32 v[24:25], v[24:25], v[32:33]
v_pk_add_f32 v[26:27], v[26:27], v[34:35]
s_waitcnt vmcnt(7)
v_xor_b32 v36, s32, v36
v_xor_b32 v37, s33, v37
v_xor_b32 v38, s34, v38
v_xor_b32 v39, s35, v39
v_or3_b32 v76, v36, v37, v76
v_or3_b32 v76, v38, v39, v76
v_pk_add_f32 v[24:25], v[24:25], v[36:37]
v_pk_add_f32 v[26:27], v[26:27], v[38:39]
s_waitcnt vmcnt(6)
v_xor_b32 v40, s32, v40
v_xor_b32 v41, s33, v41
v_xor_b32 v42, s34, v42
v_xor_b32 v43, s35, v43
v_or3_b32 v76, v40, v41, v76
v_or3_b32 v76, v42, v43, v76
v_pk_add_f32 v[24:25], v[24:25], v[40:41]
v_pk_add_f32 v[26:27], v[26:27], v[42:43]
WS_8:
s_cbranch_execz WRET
s_waitcnt vmcnt(5)
v_xor_b32 v44, s32, v44
v_xor_b32 v45, s33, v45
v_xor_b32 v46, s34, v46
v_xor_b32 v47, s35, v47
v_or3_b32 v76, v44, v45, v76
v_or3_b32 v76, v46, v47, v76
v_pk_add_f32 v[24:25], v[24:25], v[44:45]
v_pk_add_f32 v[26:27], v[26:27], v[46:47]
v_pk_add_f32 v[192:193], v[192:193], s[60:61]
s_waitcnt vmcnt(4)
v_xor_b32 v48, s32, v48
v_xor_b32 v49, s33, v49
v_xor_b32 v50, s34, v50
v_xor_b32 v51, s35, v51
v_or3_b32 v76, v48, v49, v76
v_or3_b32 v76, v50, v51, v76
v_pk_add_f32 v[24:25], v[24:25], v[48:49]
v_pk_add_f32 v[26:27], v[26:27], v[50:51]
v_pk_add_f32 v[196:197], v[196:197], s[60:61]
s_waitcnt vmcnt(3)
v_xor_b32 v52, s32, v52
v_xor_b32 v53, s33, v53
v_xor_b32 v54, s34, v54
v_xor_b32 v55, s35, v55
v_or3_b32 v76, v52, v53, v76
v_or3_b32 v76, v54, v55, v76
v_pk_add_f32 v[24:25], v[24:25], v[52:53]
v_pk_add_f32 v[26:27], v[26:27], v[54:55]
v_pk_add_f32 v[200:201], v[200:201], s[60:61]
s_waitcnt vmcnt(2)
v_xor_b32 v56, s32, v56
v_xor_b32 v57, s33, v57
v_xor_b32 v58, s34, v58
v_xor_b32 v59, s35, v59
v_or3_b32 v76, v56, v57, v76
v_or3_b32 v76, v58, v59, v76
v_pk_add_f32 v[24:25], v[24:25], v[56:57]
v_pk_add_f32 v[26:27], v[26:27], v[58:59]
v_pk_add_f32 v[204:205], v[204:205], s[60:61]
s_waitcnt vmcnt(1)
v_xor_b32 v60, s32, v60
v_xor_b32 v61, s33, v61
v_xor_b32 v62, s34, v62
v_xor_b32 v63, s35, v63
v_or3_b32 v76, v60, v61, v76
v_or3_b32 v76, v62, v63, v76
v_pk_add_f32 v[24:25], v[24:25], v[60:61]
v_pk_add_f32 v[26:27], v[26:27], v[62:63]
v_pk_add_f32 v[208:209], v[208:209], s[60:61]
s_waitcnt vmcnt(0)
v_xor_b32 v64, s32, v64
v_xor_b32 v65, s33, v65
v_xor_b32 v66, s34, v66
v_xor_b32 v67, s35, v67
v_or3_b32 v76, v64, v65, v76
v_or3_b32 v76, v66, v67, v76
v_pk_add_f32 v[24:25], v[24:25], v[64:65]
v_pk_add_f32 v[26:27], v[26:27], v[66:67]
v_pk_add_f32 v[212:213], v[212:213], s[60:61]
v_pk_mul_f32 v[192:193], v[192:193], v[224:225]
v_pk_mul_f32 v[196:197], v[196:197], v[226:227]
v_pk_mul_f32 v[200:201], v[200:201], v[228:229]
v_pk_mul_f32 v[204:205], v[204:205], v[230:231]
v_pk_mul_f32 v[208:209], v[208:209], v[232:233]
v_pk_mul_f32 v[212:213], v[212:213], v[234:235]
v_and_b32 v76, s62, v76
v_cmp_ne_u32 vcc, 0, v76
v_cvt_pk_bf16_f32 v78, v24, v25
v_cvt_pk_bf16_f32 v79, v26, v27
s_cbranch_vccnz M_gw
s_nop 0
v_mfma_f32_16x16x16_bf16 v[24:27], v[78:79], v[0:1], 0
v_rcp_f32 v192, v192
v_mfma_f32_16x16x16_bf16 v[28:31], v[78:79], v[2:3], 0
v_rcp_f32 v193, v193
v_mfma_f32_16x16x16_bf16 v[32:35], v[78:79], v[4:5], 0
v_rcp_f32 v196, v196
v_mfma_f32_16x16x16_bf16 v[36:39], v[78:79], v[6:7], 0
v_rcp_f32 v197, v197
v_mfma_f32_16x16x16_bf16 v[40:43], v[78:79], v[8:9], 0
v_rcp_f32 v200, v200
v_mfma_f32_16x16x16_bf16 v[44:47], v[78:79], v[10:11], 0
v_rcp_f32 v201, v201
v_mfma_f32_16x16x16_bf16 v[48:51], v[78:79], v[12:13], 0
v_rcp_f32 v204, v204
v_mfma_f32_16x16x16_bf16 v[52:55], v[78:79], v[14:15], 0
v_rcp_f32 v205, v205
v_mfma_f32_16x16x16_bf16 v[56:59], v[78:79], v[16:17], 0
v_rcp_f32 v208, v208
v_mfma_f32_16x16x16_bf16 v[60:63], v[78:79], v[18:19], 0
v_rcp_f32 v209, v209
v_mfma_f32_16x16x16_bf16 v[64:67], v[78:79], v[20:21], 0
v_rcp_f32 v212, v212
v_mfma_f32_16x16x16_bf16 v[68:71], v[78:79], v[22:23], 0
v_rcp_f32 v213, v213
v_pk_mul_f32 v[24:25], v[24:25], v[192:193] op_sel_hi:[1,0]
v_pk_mul_f32 v[26:27], v[26:27], v[192:193] op_sel_hi:[1,0]
v_cvt_pk_bf16_f32 v24, v24, v25
v_cvt_pk_bf16_f32 v25, v26, v27
v_pk_mul_f32 v[28:29], v[28:29], v[192:193] op_sel:[0,1]
v_pk_mul_f32 v[30:31], v[30:31], v[192:193] op_sel:[0,1]
v_cvt_pk_bf16_f32 v26, v28, v29
v_cvt_pk_bf16_f32 v27, v30, v31
v_pk_mul_f32 v[32:33], v[32:33], v[196:197] op_sel_hi:[1,0]
v_permlane16_swap_b32 v24, v26
v_permlane16_swap_b32 v25, v27
v_pk_mul_f32 v[34:35], v[34:35], v[196:197] op_sel_hi:[1,0]
buffer_store_dwordx4 v[24:27], v251, s[44:47], s36 offen sc1
v_pk_mul_f32 v[36:37], v[36:37], v[196:197] op_sel:[0,1]
v_pk_mul_f32 v[38:39], v[38:39], v[196:197] op_sel:[0,1]
v_cvt_pk_bf16_f32 v32, v32, v33
v_cvt_pk_bf16_f32 v33, v34, v35
v_cvt_pk_bf16_f32 v34, v36, v37
v_cvt_pk_bf16_f32 v35, v38, v39
v_pk_mul_f32 v[40:41], v[40:41], v[200:201] op_sel_hi:[1,0]
v_permlane16_swap_b32 v32, v34
v_permlane16_swap_b32 v33, v35
v_pk_mul_f32 v[42:43], v[42:43], v[200:201] op_sel_hi:[1,0]
buffer_store_dwordx4 v[32:35], v251, s[44:47], s37 offen sc1
v_pk_mul_f32 v[44:45], v[44:45], v[200:201] op_sel:[0,1]
v_pk_mul_f32 v[46:47], v[46:47], v[200:201] op_sel:[0,1]
v_cvt_pk_bf16_f32 v40, v40, v41
v_cvt_pk_bf16_f32 v41, v42, v43
v_cvt_pk_bf16_f32 v42, v44, v45
v_cvt_pk_bf16_f32 v43, v46, v47
v_pk_mul_f32 v[48:49], v[48:49], v[204:205] op_sel_hi:[1,0]
v_permlane16_swap_b32 v40, v42
v_permlane16_swap_b32 v41, v43
v_pk_mul_f32 v[50:51], v[50:51], v[204:205] op_sel_hi:[1,0]
buffer_store_dwordx4 v[40:43], v251, s[44:47], s38 offen sc1
v_pk_mul_f32 v[52:53], v[52:53], v[204:205] op_sel:[0,1]
v_pk_mul_f32 v[54:55], v[54:55], v[204:205] op_sel:[0,1]
v_cvt_pk_bf16_f32 v48, v48, v49
v_cvt_pk_bf16_f32 v49, v50, v51
v_cvt_pk_bf16_f32 v50, v52, v53
v_cvt_pk_bf16_f32 v51, v54, v55
v_pk_mul_f32 v[56:57], v[56:57], v[208:209] op_sel_hi:[1,0]
v_permlane16_swap_b32 v48, v50
v_permlane16_swap_b32 v49, v51
v_pk_mul_f32 v[58:59], v[58:59], v[208:209] op_sel_hi:[1,0]
buffer_store_dwordx4 v[48:51], v251, s[44:47], s39 offen sc1
v_pk_mul_f32 v[60:61], v[60:61], v[208:209] op_sel:[0,1]
v_pk_mul_f32 v[62:63], v[62:63], v[208:209] op_sel:[0,1]
v_cvt_pk_bf16_f32 v56, v56, v57
v_cvt_pk_bf16_f32 v57, v58, v59
v_cvt_pk_bf16_f32 v58, v60, v61
v_cvt_pk_bf16_f32 v59, v62, v63
v_pk_mul_f32 v[64:65], v[64:65], v[212:213] op_sel_hi:[1,0]
v_permlane16_swap_b32 v56, v58
v_permlane16_swap_b32 v57, v59
v_pk_mul_f32 v[66:67], v[66:67], v[212:213] op_sel_hi:[1,0]
buffer_store_dwordx4 v[56:59], v251, s[4:7], s40 offen sc1
v_pk_mul_f32 v[68:69], v[68:69], v[212:213] op_sel:[0,1]
v_pk_mul_f32 v[70:71], v[70:71], v[212:213] op_sel:[0,1]
v_cvt_pk_bf16_f32 v64, v64, v65
v_cvt_pk_bf16_f32 v65, v66, v67
v_cvt_pk_bf16_f32 v66, v68, v69
v_cvt_pk_bf16_f32 v67, v70, v71
s_nop 0
v_permlane16_swap_b32 v64, v66
v_permlane16_swap_b32 v65, v67
buffer_store_dwordx4 v[64:67], v251, s[4:7], s41 offen sc1
M_s2:
s_barrier
buffer_load_dwordx4 v[32:35], v248, s[44:47], s76 offen offset:0 sc1
buffer_load_dwordx4 v[36:39], v248, s[44:47], s76 offen offset:256 sc1
buffer_load_dwordx4 v[40:43], v248, s[44:47], s76 offen offset:2048 sc1
buffer_load_dwordx4 v[44:47], v248, s[44:47], s76 offen offset:2304 sc1
s_add_u32 s76, s76, 4096
buffer_load_dwordx4 v[48:51], v248, s[44:47], s76 offen offset:0 sc1
buffer_load_dwordx4 v[52:55], v248, s[44:47], s76 offen offset:256 sc1
buffer_load_dwordx4 v[56:59], v248, s[44:47], s76 offen offset:2048 sc1
buffer_load_dwordx4 v[60:63], v248, s[44:47], s76 offen offset:2304 sc1
s_add_u32 s76, s76, 4096
buffer_load_dwordx4 v[64:67], v248, s[44:47], s76 offen offset:0 sc1
buffer_load_dwordx4 v[68:71], v248, s[44:47], s76 offen offset:256 sc1
v_add_u32 v244, 4294868992, v244
v_add_u32 v245, 4294868992, v245
v_add_u32 v246, 4294868992, v246
v_add_u32 v247, 4294868992, v247
ds_read_b64_tr_b16 v[192:193], v244 offset:0
ds_read_b64_tr_b16 v[194:195], v244 offset:512
ds_read_b64_tr_b16 v[196:197], v245 offset:0
ds_read_b64_tr_b16 v[198:199], v245 offset:512
ds_read_b64_tr_b16 v[200:201], v246 offset:0
ds_read_b64_tr_b16 v[202:203], v246 offset:512
ds_read_b64_tr_b16 v[204:205], v247 offset:0
ds_read_b64_tr_b16 v[206:207], v247 offset:512
ds_read_b64_tr_b16 v[208:209], v244 offset:8192
ds_read_b64_tr_b16 v[210:211], v244 offset:8704
ds_read_b64_tr_b16 v[212:213], v245 offset:8192
ds_read_b64_tr_b16 v[214:215], v245 offset:8704
ds_read_b64_tr_b16 v[216:217], v246 offset:8192
ds_read_b64_tr_b16 v[218:219], v246 offset:8704
ds_read_b64_tr_b16 v[220:221], v247 offset:8192
ds_read_b64_tr_b16 v[222:223], v247 offset:8704
ds_read_b64_tr_b16 v[224:225], v244 offset:16384
ds_read_b64_tr_b16 v[226:227], v244 offset:16896
ds_read_b64_tr_b16 v[228:229], v245 offset:16384
ds_read_b64_tr_b16 v[230:231], v245 offset:16896
ds_read_b64_tr_b16 v[232:233], v246 offset:16384
ds_read_b64_tr_b16 v[234:235], v246 offset:16896
ds_read_b64_tr_b16 v[236:237], v247 offset:16384
ds_read_b64_tr_b16 v[238:239], v247 offset:16896
s_waitcnt vmcnt(8) lgkmcnt(0)
s_cmp_lt_u32 s27, 8
s_cbranch_scc0 M_noflag
s_mov_b64 exec, 1
buffer_store_dwordx2 v[252:253], v251, s[44:47], s71 offen sc1
s_mov_b64 exec, -1
s_nop 2
M_noflag:
v_mfma_f32_16x16x32_bf16 v[0:3], v[80:83], v[32:35], 0
s_barrier
v_mfma_f32_16x16x32_bf16 v[16:19], v[80:83], v[36:39], 0
buffer_load_dwordx4 v[72:75], v248, s[44:47], s76 offen offset:2048 sc1
v_mfma_f32_16x16x32_bf16 v[20:23], v[84:87], v[36:39], 0
v_mfma_f32_16x16x32_bf16 v[4:7], v[84:87], v[32:35], 0
v_mfma_f32_16x16x32_bf16 v[8:11], v[88:91], v[32:35], 0
v_mfma_f32_16x16x32_bf16 v[24:27], v[88:91], v[36:39], 0
buffer_load_dwordx4 v[76:79], v248, s[44:47], s76 offen offset:2304 sc1
v_mfma_f32_16x16x32_bf16 v[28:31], v[92:95], v[36:39], 0
v_mfma_f32_16x16x32_bf16 v[12:15], v[92:95], v[32:35], 0
s_waitcnt vmcnt(8)
v_mfma_f32_16x16x32_bf16 v[0:3], v[96:99], v[40:43], v[0:3]
v_mfma_f32_16x16x32_bf16 v[16:19], v[96:99], v[44:47], v[16:19]
s_add_u32 s76, s76, 4096
buffer_load_dwordx4 v[32:35], v248, s[44:47], s76 offen offset:0 sc1
v_mfma_f32_16x16x32_bf16 v[20:23], v[100:103], v[44:47], v[20:23]
v_mfma_f32_16x16x32_bf16 v[4:7], v[100:103], v[40:43], v[4:7]
v_mfma_f32_16x16x32_bf16 v[8:11], v[104:107], v[40:43], v[8:11]
v_mfma_f32_16x16x32_bf16 v[24:27], v[104:107], v[44:47], v[24:27]
buffer_load_dwordx4 v[36:39], v248, s[44:47], s76 offen offset:256 sc1
v_mfma_f32_16x16x32_bf16 v[28:31], v[108:111], v[44:47], v[28:31]
v_mfma_f32_16x16x32_bf16 v[12:15], v[108:111], v[40:43], v[12:15]
s_waitcnt vmcnt(8)
v_mfma_f32_16x16x32_bf16 v[0:3], v[112:115], v[48:51], v[0:3]
v_mfma_f32_16x16x32_bf16 v[16:19], v[112:115], v[52:55], v[16:19]
buffer_load_dwordx4 v[40:43], v248, s[44:47], s76 offen offset:2048 sc1
v_mfma_f32_16x16x32_bf16 v[20:23], v[116:119], v[52:55], v[20:23]
v_mfma_f32_16x16x32_bf16 v[4:7], v[116:119], v[48:51], v[4:7]
v_mfma_f32_16x16x32_bf16 v[8:11], v[120:123], v[48:51], v[8:11]
v_mfma_f32_16x16x32_bf16 v[24:27], v[120:123], v[52:55], v[24:27]
buffer_load_dwordx4 v[44:47], v248, s[44:47], s76 offen offset:2304 sc1
v_mfma_f32_16x16x32_bf16 v[28:31], v[124:127], v[52:55], v[28:31]
v_mfma_f32_16x16x32_bf16 v[12:15], v[124:127], v[48:51], v[12:15]
s_waitcnt vmcnt(8)
v_mfma_f32_16x16x32_bf16 v[0:3], v[128:131], v[56:59], v[0:3]
v_mfma_f32_16x16x32_bf16 v[16:19], v[128:131], v[60:63], v[16:19]
s_add_u32 s76, s76, 4096
buffer_load_dwordx4 v[48:51], v248, s[44:47], s76 offen offset:0 sc1
v_mfma_f32_16x16x32_bf16 v[20:23], v[132:135], v[60:63], v[20:23]
v_mfma_f32_16x16x32_bf16 v[4:7], v[132:135], v[56:59], v[4:7]
v_mfma_f32_16x16x32_bf16 v[8:11], v[136:139], v[56:59], v[8:11]
v_mfma_f32_16x16x32_bf16 v[24:27], v[136:139], v[60:63], v[24:27]
buffer_load_dwordx4 v[52:55], v248, s[44:47], s76 offen offset:256 sc1
v_mfma_f32_16x16x32_bf16 v[28:31], v[140:143], v[60:63], v[28:31]
v_mfma_f32_16x16x32_bf16 v[12:15], v[140:143], v[56:59], v[12:15]
s_waitcnt vmcnt(8)
v_mfma_f32_16x16x32_bf16 v[0:3], v[144:147], v[64:67], v[0:3]
v_mfma_f32_16x16x32_bf16 v[16:19], v[144:147], v[68:71], v[16:19]
buffer_load_dwordx4 v[56:59], v248, s[44:47], s76 offen offset:2048 sc1
v_mfma_f32_16x16x32_bf16 v[20:23], v[148:151], v[68:71], v[20:23]
v_mfma_f32_16x16x32_bf16 v[4:7], v[148:151], v[64:67], v[4:7]
v_mfma_f32_16x16x32_bf16 v[8:11], v[152:155], v[64:67], v[8:11]
v_mfma_f32_16x16x32_bf16 v[24:27], v[152:155], v[68:71], v[24:27]
buffer_load_dwordx4 v[60:63], v248, s[44:47], s76 offen offset:2304 sc1
v_mfma_f32_16x16x32_bf16 v[28:31], v[156:159], v[68:71], v[28:31]
v_mfma_f32_16x16x32_bf16 v[12:15], v[156:159], v[64:67], v[12:15]
s_waitcnt vmcnt(8)
v_mfma_f32_16x16x32_bf16 v[0:3], v[160:163], v[72:75], v[0:3]
v_mfma_f32_16x16x32_bf16 v[16:19], v[160:163], v[76:79], v[16:19]
s_add_u32 s76, s76, 4096
buffer_load_dwordx4 v[64:67], v248, s[44:47], s76 offen offset:0 sc1
v_mfma_f32_16x16x32_bf16 v[20:23], v[164:167], v[76:79], v[20:23]
v_mfma_f32_16x16x32_bf16 v[4:7], v[164:167], v[72:75], v[4:7]
v_mfma_f32_16x16x32_bf16 v[8:11], v[168:171], v[72:75], v[8:11]
v_mfma_f32_16x16x32_bf16 v[24:27], v[168:171], v[76:79], v[24:27]
buffer_load_dwordx4 v[68:71], v248, s[44:47], s76 offen offset:256 sc1
v_mfma_f32_16x16x32_bf16 v[28:31], v[172:175], v[76:79], v[28:31]
v_mfma_f32_16x16x32_bf16 v[12:15], v[172:175], v[72:75], v[12:15]
s_waitcnt vmcnt(8)
v_mfma_f32_16x16x32_bf16 v[0:3], v[176:179], v[32:35], v[0:3]
v_mfma_f32_16x16x32_bf16 v[16:19], v[176:179], v[36:39], v[16:19]
buffer_load_dwordx4 v[72:75], v248, s[44:47], s76 offen offset:2048 sc1
v_mfma_f32_16x16x32_bf16 v[20:23], v[180:183], v[36:39], v[20:23]
v_mfma_f32_16x16x32_bf16 v[4:7], v[180:183], v[32:35], v[4:7]
v_mfma_f32_16x16x32_bf16 v[8:11], v[184:187], v[32:35], v[8:11]
v_mfma_f32_16x16x32_bf16 v[24:27], v[184:187], v[36:39], v[24:27]
buffer_load_dwordx4 v[76:79], v248, s[44:47], s76 offen offset:2304 sc1
v_mfma_f32_16x16x32_bf16 v[28:31], v[188:191], v[36:39], v[28:31]
v_mfma_f32_16x16x32_bf16 v[12:15], v[188:191], v[32:35], v[12:15]
s_waitcnt vmcnt(8)
v_mfma_f32_16x16x32_bf16 v[0:3], v[192:195], v[40:43], v[0:3]
WS_9:
s_cbranch_execz WRET
v_mfma_f32_16x16x32_bf16 v[16:19], v[192:195], v[44:47], v[16:19]
s_add_u32 s76, s76, 4096
buffer_load_dwordx4 v[32:35], v248, s[44:47], s76 offen offset:0 sc1
v_mfma_f32_16x16x32_bf16 v[20:23], v[196:199], v[44:47], v[20:23]
v_mfma_f32_16x16x32_bf16 v[4:7], v[196:199], v[40:43], v[4:7]
v_mfma_f32_16x16x32_bf16 v[8:11], v[200:203], v[40:43], v[8:11]
v_mfma_f32_16x16x32_bf16 v[24:27], v[200:203], v[44:47], v[24:27]
buffer_load_dwordx4 v[36:39], v248, s[44:47], s76 offen offset:256 sc1
v_mfma_f32_16x16x32_bf16 v[28:31], v[204:207], v[44:47], v[28:31]
v_mfma_f32_16x16x32_bf16 v[12:15], v[204:207], v[40:43], v[12:15]
s_waitcnt vmcnt(8)
v_mfma_f32_16x16x32_bf16 v[0:3], v[208:211], v[48:51], v[0:3]
ds_read_b64_tr_b16 v[96:97], v244 offset:24576
v_mfma_f32_16x16x32_bf16 v[16:19], v[208:211], v[52:55], v[16:19]
ds_read_b64_tr_b16 v[98:99], v244 offset:25088
buffer_load_dwordx4 v[40:43], v248, s[44:47], s76 offen offset:2048 sc1
v_mfma_f32_16x16x32_bf16 v[20:23], v[212:215], v[52:55], v[20:23]
ds_read_b64_tr_b16 v[100:101], v245 offset:24576
v_mfma_f32_16x16x32_bf16 v[4:7], v[212:215], v[48:51], v[4:7]
ds_read_b64_tr_b16 v[102:103], v245 offset:25088
v_mfma_f32_16x16x32_bf16 v[8:11], v[216:219], v[48:51], v[8:11]
ds_read_b64_tr_b16 v[104:105], v246 offset:24576
v_mfma_f32_16x16x32_bf16 v[24:27], v[216:219], v[52:55], v[24:27]
ds_read_b64_tr_b16 v[106:107], v246 offset:25088
buffer_load_dwordx4 v[44:47], v248, s[44:47], s76 offen offset:2304 sc1
v_mfma_f32_16x16x32_bf16 v[28:31], v[220:223], v[52:55], v[28:31]
ds_read_b64_tr_b16 v[108:109], v247 offset:24576
v_mfma_f32_16x16x32_bf16 v[12:15], v[220:223], v[48:51], v[12:15]
ds_read_b64_tr_b16 v[110:111], v247 offset:25088
s_waitcnt vmcnt(8)
v_mfma_f32_16x16x32_bf16 v[0:3], v[224:227], v[56:59], v[0:3]
ds_read_b64_tr_b16 v[112:113], v244 offset:32768
v_mfma_f32_16x16x32_bf16 v[16:19], v[224:227], v[60:63], v[16:19]
ds_read_b64_tr_b16 v[114:115], v244 offset:33280
s_add_u32 s76, s76, 4096
buffer_load_dwordx4 v[48:51], v248, s[44:47], s76 offen offset:0 sc1
v_mfma_f32_16x16x32_bf16 v[20:23], v[228:231], v[60:63], v[20:23]
ds_read_b64_tr_b16 v[116:117], v245 offset:32768
v_mfma_f32_16x16x32_bf16 v[4:7], v[228:231], v[56:59], v[4:7]
ds_read_b64_tr_b16 v[118:119], v245 offset:33280
v_mfma_f32_16x16x32_bf16 v[8:11], v[232:235], v[56:59], v[8:11]
ds_read_b64_tr_b16 v[120:121], v246 offset:32768
v_mfma_f32_16x16x32_bf16 v[24:27], v[232:235], v[60:63], v[24:27]
ds_read_b64_tr_b16 v[122:123], v246 offset:33280
buffer_load_dwordx4 v[52:55], v248, s[44:47], s76 offen offset:256 sc1
v_mfma_f32_16x16x32_bf16 v[28:31], v[236:239], v[60:63], v[28:31]
ds_read_b64_tr_b16 v[124:125], v247 offset:32768
v_mfma_f32_16x16x32_bf16 v[12:15], v[236:239], v[56:59], v[12:15]
ds_read_b64_tr_b16 v[126:127], v247 offset:33280
s_waitcnt vmcnt(8) lgkmcnt(8)
v_mfma_f32_16x16x32_bf16 v[0:3], v[96:99], v[64:67], v[0:3]
ds_read_b64_tr_b16 v[80:81], v244 offset:40960
v_mfma_f32_16x16x32_bf16 v[16:19], v[96:99], v[68:71], v[16:19]
ds_read_b64_tr_b16 v[82:83], v244 offset:41472
buffer_load_dwordx4 v[56:59], v248, s[44:47], s76 offen offset:2048 sc1
v_mfma_f32_16x16x32_bf16 v[20:23], v[100:103], v[68:71], v[20:23]
ds_read_b64_tr_b16 v[84:85], v245 offset:40960
v_mfma_f32_16x16x32_bf16 v[4:7], v[100:103], v[64:67], v[4:7]
ds_read_b64_tr_b16 v[86:87], v245 offset:41472
v_mfma_f32_16x16x32_bf16 v[8:11], v[104:107], v[64:67], v[8:11]
ds_read_b64_tr_b16 v[88:89], v246 offset:40960
v_mfma_f32_16x16x32_bf16 v[24:27], v[104:107], v[68:71], v[24:27]
ds_read_b64_tr_b16 v[90:91], v246 offset:41472
buffer_load_dwordx4 v[60:63], v248, s[44:47], s76 offen offset:2304 sc1
v_mfma_f32_16x16x32_bf16 v[28:31], v[108:111], v[68:71], v[28:31]
ds_read_b64_tr_b16 v[92:93], v247 offset:40960
v_mfma_f32_16x16x32_bf16 v[12:15], v[108:111], v[64:67], v[12:15]
ds_read_b64_tr_b16 v[94:95], v247 offset:41472
s_waitcnt vmcnt(8) lgkmcnt(8)
v_mfma_f32_16x16x32_bf16 v[0:3], v[112:115], v[72:75], v[0:3]
ds_read_b64_tr_b16 v[96:97], v244 offset:49152
v_mfma_f32_16x16x32_bf16 v[16:19], v[112:115], v[76:79], v[16:19]
ds_read_b64_tr_b16 v[98:99], v244 offset:49664
s_add_u32 s76, s76, 4096
buffer_load_dwordx4 v[64:67], v248, s[44:47], s76 offen offset:0 sc1
v_mfma_f32_16x16x32_bf16 v[20:23], v[116:119], v[76:79], v[20:23]
ds_read_b64_tr_b16 v[100:101], v245 offset:49152
v_mfma_f32_16x16x32_bf16 v[4:7], v[116:119], v[72:75], v[4:7]
ds_read_b64_tr_b16 v[102:103], v245 offset:49664
v_mfma_f32_16x16x32_bf16 v[8:11], v[120:123], v[72:75], v[8:11]
ds_read_b64_tr_b16 v[104:105], v246 offset:49152
v_mfma_f32_16x16x32_bf16 v[24:27], v[120:123], v[76:79], v[24:27]
ds_read_b64_tr_b16 v[106:107], v246 offset:49664
buffer_load_dwordx4 v[68:71], v248, s[44:47], s76 offen offset:256 sc1
v_mfma_f32_16x16x32_bf16 v[28:31], v[124:127], v[76:79], v[28:31]
ds_read_b64_tr_b16 v[108:109], v247 offset:49152
v_mfma_f32_16x16x32_bf16 v[12:15], v[124:127], v[72:75], v[12:15]
ds_read_b64_tr_b16 v[110:111], v247 offset:49664
s_waitcnt vmcnt(8) lgkmcnt(8)
v_mfma_f32_16x16x32_bf16 v[0:3], v[80:83], v[32:35], v[0:3]
s_barrier
ds_read_b64_tr_b16 v[112:113], v244 offset:57344
v_mfma_f32_16x16x32_bf16 v[16:19], v[80:83], v[36:39], v[16:19]
ds_read_b64_tr_b16 v[114:115], v244 offset:57856
buffer_load_dwordx4 v[72:75], v248, s[44:47], s76 offen offset:2048 sc1
v_mfma_f32_16x16x32_bf16 v[20:23], v[84:87], v[36:39], v[20:23]
ds_read_b64_tr_b16 v[116:117], v245 offset:57344
v_mfma_f32_16x16x32_bf16 v[4:7], v[84:87], v[32:35], v[4:7]
ds_read_b64_tr_b16 v[118:119], v245 offset:57856
v_mfma_f32_16x16x32_bf16 v[8:11], v[88:91], v[32:35], v[8:11]
ds_read_b64_tr_b16 v[120:121], v246 offset:57344
v_mfma_f32_16x16x32_bf16 v[24:27], v[88:91], v[36:39], v[24:27]
ds_read_b64_tr_b16 v[122:123], v246 offset:57856
buffer_load_dwordx4 v[76:79], v248, s[44:47], s76 offen offset:2304 sc1
v_mfma_f32_16x16x32_bf16 v[28:31], v[92:95], v[36:39], v[28:31]
ds_read_b64_tr_b16 v[124:125], v247 offset:57344
v_mfma_f32_16x16x32_bf16 v[12:15], v[92:95], v[32:35], v[12:15]
ds_read_b64_tr_b16 v[126:127], v247 offset:57856
s_waitcnt vmcnt(8) lgkmcnt(8)
v_mfma_f32_16x16x32_bf16 v[0:3], v[96:99], v[40:43], v[0:3]
v_add_u32 v244, 65536, v244
v_add_u32 v245, 65536, v245
v_add_u32 v246, 65536, v246
v_add_u32 v247, 65536, v247
ds_read_b64_tr_b16 v[80:81], v244 offset:0
v_mfma_f32_16x16x32_bf16 v[16:19], v[96:99], v[44:47], v[16:19]
ds_read_b64_tr_b16 v[82:83], v244 offset:512
s_add_u32 s76, s76, 4096
buffer_load_dwordx4 v[32:35], v248, s[44:47], s76 offen offset:0 sc1
v_mfma_f32_16x16x32_bf16 v[20:23], v[100:103], v[44:47], v[20:23]
ds_read_b64_tr_b16 v[84:85], v245 offset:0
v_mfma_f32_16x16x32_bf16 v[4:7], v[100:103], v[40:43], v[4:7]
ds_read_b64_tr_b16 v[86:87], v245 offset:512
v_mfma_f32_16x16x32_bf16 v[8:11], v[104:107], v[40:43], v[8:11]
ds_read_b64_tr_b16 v[88:89], v246 offset:0
v_mfma_f32_16x16x32_bf16 v[24:27], v[104:107], v[44:47], v[24:27]
ds_read_b64_tr_b16 v[90:91], v246 offset:512
buffer_load_dwordx4 v[36:39], v248, s[44:47], s76 offen offset:256 sc1
v_mfma_f32_16x16x32_bf16 v[28:31], v[108:111], v[44:47], v[28:31]
ds_read_b64_tr_b16 v[92:93], v247 offset:0
v_mfma_f32_16x16x32_bf16 v[12:15], v[108:111], v[40:43], v[12:15]
ds_read_b64_tr_b16 v[94:95], v247 offset:512
s_waitcnt vmcnt(8) lgkmcnt(8)
v_mfma_f32_16x16x32_bf16 v[0:3], v[112:115], v[48:51], v[0:3]
ds_read_b64_tr_b16 v[96:97], v244 offset:8192
v_mfma_f32_16x16x32_bf16 v[16:19], v[112:115], v[52:55], v[16:19]
ds_read_b64_tr_b16 v[98:99], v244 offset:8704
buffer_load_dwordx4 v[40:43], v248, s[44:47], s76 offen offset:2048 sc1
v_mfma_f32_16x16x32_bf16 v[20:23], v[116:119], v[52:55], v[20:23]
ds_read_b64_tr_b16 v[100:101], v245 offset:8192
v_mfma_f32_16x16x32_bf16 v[4:7], v[116:119], v[48:51], v[4:7]
ds_read_b64_tr_b16 v[102:103], v245 offset:8704
v_mfma_f32_16x16x32_bf16 v[8:11], v[120:123], v[48:51], v[8:11]
ds_read_b64_tr_b16 v[104:105], v246 offset:8192
v_mfma_f32_16x16x32_bf16 v[24:27], v[120:123], v[52:55], v[24:27]
ds_read_b64_tr_b16 v[106:107], v246 offset:8704
buffer_load_dwordx4 v[44:47], v248, s[44:47], s76 offen offset:2304 sc1
v_mfma_f32_16x16x32_bf16 v[28:31], v[124:127], v[52:55], v[28:31]
ds_read_b64_tr_b16 v[108:109], v247 offset:8192
v_mfma_f32_16x16x32_bf16 v[12:15], v[124:127], v[48:51], v[12:15]
ds_read_b64_tr_b16 v[110:111], v247 offset:8704
s_waitcnt vmcnt(8) lgkmcnt(8)
v_mfma_f32_16x16x32_bf16 v[0:3], v[80:83], v[56:59], v[0:3]
ds_read_b64_tr_b16 v[112:113], v244 offset:16384
v_mfma_f32_16x16x32_bf16 v[16:19], v[80:83], v[60:63], v[16:19]
ds_read_b64_tr_b16 v[114:115], v244 offset:16896
s_add_u32 s76, s76, 4096
buffer_load_dwordx4 v[48:51], v248, s[44:47], s76 offen offset:0 sc1
v_mfma_f32_16x16x32_bf16 v[20:23], v[84:87], v[60:63], v[20:23]
ds_read_b64_tr_b16 v[116:117], v245 offset:16384
v_mfma_f32_16x16x32_bf16 v[4:7], v[84:87], v[56:59], v[4:7]
ds_read_b64_tr_b16 v[118:119], v245 offset:16896
v_mfma_f32_16x16x32_bf16 v[8:11], v[88:91], v[56:59], v[8:11]
ds_read_b64_tr_b16 v[120:121], v246 offset:16384
v_mfma_f32_16x16x32_bf16 v[24:27], v[88:91], v[60:63], v[24:27]
ds_read_b64_tr_b16 v[122:123], v246 offset:16896
buffer_load_dwordx4 v[52:55], v248, s[44:47], s76 offen offset:256 sc1
v_mfma_f32_16x16x32_bf16 v[28:31], v[92:95], v[60:63], v[28:31]
ds_read_b64_tr_b16 v[124:125], v247 offset:16384
v_mfma_f32_16x16x32_bf16 v[12:15], v[92:95], v[56:59], v[12:15]
ds_read_b64_tr_b16 v[126:127], v247 offset:16896
s_waitcnt vmcnt(8) lgkmcnt(8)
v_mfma_f32_16x16x32_bf16 v[0:3], v[96:99], v[64:67], v[0:3]
ds_read_b64_tr_b16 v[80:81], v244 offset:24576
v_mfma_f32_16x16x32_bf16 v[16:19], v[96:99], v[68:71], v[16:19]
ds_read_b64_tr_b16 v[82:83], v244 offset:25088
v_add_u32 v249, s79, v248
buffer_load_dwordx4 v[56:59], v249, s[44:47], s74 offen offset:0 sc1
v_mfma_f32_16x16x32_bf16 v[20:23], v[100:103], v[68:71], v[20:23]
ds_read_b64_tr_b16 v[84:85], v245 offset:24576
v_mfma_f32_16x16x32_bf16 v[4:7], v[100:103], v[64:67], v[4:7]
ds_read_b64_tr_b16 v[86:87], v245 offset:25088
v_mfma_f32_16x16x32_bf16 v[8:11], v[104:107], v[64:67], v[8:11]
ds_read_b64_tr_b16 v[88:89], v246 offset:24576
v_mfma_f32_16x16x32_bf16 v[24:27], v[104:107], v[68:71], v[24:27]
ds_read_b64_tr_b16 v[90:91], v246 offset:25088
buffer_load_dwordx4 v[60:63], v249, s[44:47], s74 offen offset:256 sc1
v_mfma_f32_16x16x32_bf16 v[28:31], v[108:111], v[68:71], v[28:31]
ds_read_b64_tr_b16 v[92:93], v247 offset:24576
v_mfma_f32_16x16x32_bf16 v[12:15], v[108:111], v[64:67], v[12:15]
ds_read_b64_tr_b16 v[94:95], v247 offset:25088
s_waitcnt vmcnt(8) lgkmcnt(8)
v_mfma_f32_16x16x32_bf16 v[0:3], v[112:115], v[72:75], v[0:3]
s_barrier
ds_read_b64_tr_b16 v[96:97], v244 offset:32768
v_mfma_f32_16x16x32_bf16 v[16:19], v[112:115], v[76:79], v[16:19]
ds_read_b64_tr_b16 v[98:99], v244 offset:33280
buffer_load_dwordx4 v[64:67], v248, s[44:47], s78 offen offset:0 sc1
v_mfma_f32_16x16x32_bf16 v[20:23], v[116:119], v[76:79], v[20:23]
ds_read_b64_tr_b16 v[100:101], v245 offset:32768
v_mfma_f32_16x16x32_bf16 v[4:7], v[116:119], v[72:75], v[4:7]
ds_read_b64_tr_b16 v[102:103], v245 offset:33280
v_mfma_f32_16x16x32_bf16 v[8:11], v[120:123], v[72:75], v[8:11]
ds_read_b64_tr_b16 v[104:105], v246 offset:32768
v_mfma_f32_16x16x32_bf16 v[24:27], v[120:123], v[76:79], v[24:27]
ds_read_b64_tr_b16 v[106:107], v246 offset:33280
buffer_load_dwordx4 v[68:71], v248, s[44:47], s78 offen offset:256 sc1
v_mfma_f32_16x16x32_bf16 v[28:31], v[124:127], v[76:79], v[28:31]
ds_read_b64_tr_b16 v[108:109], v247 offset:32768
v_mfma_f32_16x16x32_bf16 v[12:15], v[124:127], v[72:75], v[12:15]
ds_read_b64_tr_b16 v[110:111], v247 offset:33280
s_waitcnt vmcnt(8) lgkmcnt(8)
v_mfma_f32_16x16x32_bf16 v[0:3], v[80:83], v[32:35], v[0:3]
ds_read_b64_tr_b16 v[112:113], v244 offset:40960
v_mfma_f32_16x16x32_bf16 v[16:19], v[80:83], v[36:39], v[16:19]
ds_read_b64_tr_b16 v[114:115], v244 offset:41472
buffer_load_dwordx4 v[72:75], v248, s[44:47], s78 offen offset:2048 sc1
v_mfma_f32_16x16x32_bf16 v[20:23], v[84:87], v[36:39], v[20:23]
ds_read_b64_tr_b16 v[116:117], v245 offset:40960
v_mfma_f32_16x16x32_bf16 v[4:7], v[84:87], v[32:35], v[4:7]
ds_read_b64_tr_b16 v[118:119], v245 offset:41472
v_mfma_f32_16x16x32_bf16 v[8:11], v[88:91], v[32:35], v[8:11]
ds_read_b64_tr_b16 v[120:121], v246 offset:40960
v_mfma_f32_16x16x32_bf16 v[24:27], v[88:91], v[36:39], v[24:27]
ds_read_b64_tr_b16 v[122:123], v246 offset:41472
buffer_load_dwordx4 v[76:79], v248, s[44:47], s78 offen offset:2304 sc1
v_mfma_f32_16x16x32_bf16 v[28:31], v[92:95], v[36:39], v[28:31]
ds_read_b64_tr_b16 v[124:125], v247 offset:40960
v_mfma_f32_16x16x32_bf16 v[12:15], v[92:95], v[32:35], v[12:15]
ds_read_b64_tr_b16 v[126:127], v247 offset:41472
s_waitcnt vmcnt(8) lgkmcnt(8)
v_mfma_f32_16x16x32_bf16 v[0:3], v[96:99], v[40:43], v[0:3]
v_subrev_u32 v244, s77, v244
v_subrev_u32 v245, s77, v245
v_subrev_u32 v246, s77, v246
v_subrev_u32 v247, s77, v247
v_add_u32 v244, 32768, v244
v_add_u32 v245, 32768, v245
v_add_u32 v246, 32768, v246
v_add_u32 v247, 32768, v247
ds_read_b64_tr_b16 v[80:81], v244 offset:57344
v_mfma_f32_16x16x32_bf16 v[16:19], v[96:99], v[44:47], v[16:19]
ds_read_b64_tr_b16 v[82:83], v244 offset:57856
s_add_u32 s78, s78, 4096
buffer_load_dwordx4 v[32:35], v248, s[44:47], s78 offen offset:0 sc1
v_mfma_f32_16x16x32_bf16 v[20:23], v[100:103], v[44:47], v[20:23]
ds_read_b64_tr_b16 v[84:85], v245 offset:57344
v_mfma_f32_16x16x32_bf16 v[4:7], v[100:103], v[40:43], v[4:7]
ds_read_b64_tr_b16 v[86:87], v245 offset:57856
v_mfma_f32_16x16x32_bf16 v[8:11], v[104:107], v[40:43], v[8:11]
ds_read_b64_tr_b16 v[88:89], v246 offset:57344
v_mfma_f32_16x16x32_bf16 v[24:27], v[104:107], v[44:47], v[24:27]
ds_read_b64_tr_b16 v[90:91], v246 offset:57856
buffer_load_dwordx4 v[36:39], v248, s[44:47], s78 offen offset:256 sc1
v_mfma_f32_16x16x32_bf16 v[28:31], v[108:111], v[44:47], v[28:31]
ds_read_b64_tr_b16 v[92:93], v247 offset:57344
v_mfma_f32_16x16x32_bf16 v[12:15], v[108:111], v[40:43], v[12:15]
ds_read_b64_tr_b16 v[94:95], v247 offset:57856
s_waitcnt vmcnt(8) lgkmcnt(8)
v_mfma_f32_16x16x32_bf16 v[0:3], v[112:115], v[48:51], v[0:3]
v_add_u32 v244, s77, v244
v_add_u32 v245, s77, v245
v_add_u32 v246, s77, v246
v_add_u32 v247, s77, v247
ds_read_b64_tr_b16 v[96:97], v244 offset:16384
v_mfma_f32_16x16x32_bf16 v[16:19], v[112:115], v[52:55], v[16:19]
ds_read_b64_tr_b16 v[98:99], v244 offset:16896
WS_10:
s_cbranch_execz WRET
buffer_load_dwordx4 v[40:43], v248, s[44:47], s78 offen offset:2048 sc1
v_mfma_f32_16x16x32_bf16 v[20:23], v[116:119], v[52:55], v[20:23]
ds_read_b64_tr_b16 v[100:101], v245 offset:16384
v_mfma_f32_16x16x32_bf16 v[4:7], v[116:119], v[48:51], v[4:7]
ds_read_b64_tr_b16 v[102:103], v245 offset:16896
v_mfma_f32_16x16x32_bf16 v[8:11], v[120:123], v[48:51], v[8:11]
ds_read_b64_tr_b16 v[104:105], v246 offset:16384
v_mfma_f32_16x16x32_bf16 v[24:27], v[120:123], v[52:55], v[24:27]
ds_read_b64_tr_b16 v[106:107], v246 offset:16896
buffer_load_dwordx4 v[44:47], v248, s[44:47], s78 offen offset:2304 sc1
v_mfma_f32_16x16x32_bf16 v[28:31], v[124:127], v[52:55], v[28:31]
ds_read_b64_tr_b16 v[108:109], v247 offset:16384
v_mfma_f32_16x16x32_bf16 v[12:15], v[124:127], v[48:51], v[12:15]
ds_read_b64_tr_b16 v[110:111], v247 offset:16896
s_waitcnt vmcnt(8) lgkmcnt(8)
v_mfma_f32_16x16x32_bf16 v[0:3], v[80:83], v[56:59], v[0:3]
ds_read_b64_tr_b16 v[112:113], v244 offset:24576
v_mfma_f32_16x16x32_bf16 v[16:19], v[80:83], v[60:63], v[16:19]
ds_read_b64_tr_b16 v[114:115], v244 offset:25088
s_add_u32 s78, s78, 4096
buffer_load_dwordx4 v[48:51], v248, s[44:47], s78 offen offset:0 sc1
v_mfma_f32_16x16x32_bf16 v[20:23], v[84:87], v[60:63], v[20:23]
ds_read_b64_tr_b16 v[116:117], v245 offset:24576
v_mfma_f32_16x16x32_bf16 v[4:7], v[84:87], v[56:59], v[4:7]
ds_read_b64_tr_b16 v[118:119], v245 offset:25088
v_mfma_f32_16x16x32_bf16 v[8:11], v[88:91], v[56:59], v[8:11]
ds_read_b64_tr_b16 v[120:121], v246 offset:24576
v_mfma_f32_16x16x32_bf16 v[24:27], v[88:91], v[60:63], v[24:27]
ds_read_b64_tr_b16 v[122:123], v246 offset:25088
buffer_load_dwordx4 v[52:55], v248, s[44:47], s78 offen offset:256 sc1
v_mfma_f32_16x16x32_bf16 v[28:31], v[92:95], v[60:63], v[28:31]
ds_read_b64_tr_b16 v[124:125], v247 offset:24576
v_mfma_f32_16x16x32_bf16 v[12:15], v[92:95], v[56:59], v[12:15]
ds_read_b64_tr_b16 v[126:127], v247 offset:25088
s_waitcnt vmcnt(8) lgkmcnt(8)
v_mfma_f32_16x16x32_bf16 v[0:3], v[96:99], v[64:67], v[0:3]
ds_read_b64_tr_b16 v[80:81], v244 offset:32768
v_mfma_f32_16x16x32_bf16 v[16:19], v[96:99], v[68:71], v[16:19]
ds_read_b64_tr_b16 v[82:83], v244 offset:33280
buffer_load_dwordx4 v[56:59], v248, s[44:47], s78 offen offset:2048 sc1
v_mfma_f32_16x16x32_bf16 v[20:23], v[100:103], v[68:71], v[20:23]
ds_read_b64_tr_b16 v[84:85], v245 offset:32768
v_mfma_f32_16x16x32_bf16 v[4:7], v[100:103], v[64:67], v[4:7]
ds_read_b64_tr_b16 v[86:87], v245 offset:33280
v_mfma_f32_16x16x32_bf16 v[8:11], v[104:107], v[64:67], v[8:11]
ds_read_b64_tr_b16 v[88:89], v246 offset:32768
v_mfma_f32_16x16x32_bf16 v[24:27], v[104:107], v[68:71], v[24:27]
ds_read_b64_tr_b16 v[90:91], v246 offset:33280
buffer_load_dwordx4 v[60:63], v248, s[44:47], s78 offen offset:2304 sc1
v_mfma_f32_16x16x32_bf16 v[28:31], v[108:111], v[68:71], v[28:31]
ds_read_b64_tr_b16 v[92:93], v247 offset:32768
v_mfma_f32_16x16x32_bf16 v[12:15], v[108:111], v[64:67], v[12:15]
ds_read_b64_tr_b16 v[94:95], v247 offset:33280
s_waitcnt vmcnt(8) lgkmcnt(8)
v_mfma_f32_16x16x32_bf16 v[0:3], v[112:115], v[72:75], v[0:3]
ds_read_b64_tr_b16 v[96:97], v244 offset:40960
v_mfma_f32_16x16x32_bf16 v[16:19], v[112:115], v[76:79], v[16:19]
ds_read_b64_tr_b16 v[98:99], v244 offset:41472
s_add_u32 s78, s78, 4096
buffer_load_dwordx4 v[64:67], v248, s[44:47], s78 offen offset:0 sc1
v_mfma_f32_16x16x32_bf16 v[20:23], v[116:119], v[76:79], v[20:23]
ds_read_b64_tr_b16 v[100:101], v245 offset:40960
v_mfma_f32_16x16x32_bf16 v[4:7], v[116:119], v[72:75], v[4:7]
ds_read_b64_tr_b16 v[102:103], v245 offset:41472
v_mfma_f32_16x16x32_bf16 v[8:11], v[120:123], v[72:75], v[8:11]
ds_read_b64_tr_b16 v[104:105], v246 offset:40960
v_mfma_f32_16x16x32_bf16 v[24:27], v[120:123], v[76:79], v[24:27]
ds_read_b64_tr_b16 v[106:107], v246 offset:41472
buffer_load_dwordx4 v[68:71], v248, s[44:47], s78 offen offset:256 sc1
v_mfma_f32_16x16x32_bf16 v[28:31], v[124:127], v[76:79], v[28:31]
ds_read_b64_tr_b16 v[108:109], v247 offset:40960
v_mfma_f32_16x16x32_bf16 v[12:15], v[124:127], v[72:75], v[12:15]
ds_read_b64_tr_b16 v[110:111], v247 offset:41472
s_waitcnt vmcnt(8) lgkmcnt(8)
v_mfma_f32_16x16x32_bf16 v[0:3], v[80:83], v[32:35], v[0:3]
ds_read_b64_tr_b16 v[112:113], v244 offset:49152
v_mfma_f32_16x16x32_bf16 v[16:19], v[80:83], v[36:39], v[16:19]
ds_read_b64_tr_b16 v[114:115], v244 offset:49664
buffer_load_dwordx4 v[72:75], v248, s[44:47], s78 offen offset:2048 sc1
v_mfma_f32_16x16x32_bf16 v[20:23], v[84:87], v[36:39], v[20:23]
ds_read_b64_tr_b16 v[116:117], v245 offset:49152
v_mfma_f32_16x16x32_bf16 v[4:7], v[84:87], v[32:35], v[4:7]
ds_read_b64_tr_b16 v[118:119], v245 offset:49664
v_mfma_f32_16x16x32_bf16 v[8:11], v[88:91], v[32:35], v[8:11]
ds_read_b64_tr_b16 v[120:121], v246 offset:49152
v_mfma_f32_16x16x32_bf16 v[24:27], v[88:91], v[36:39], v[24:27]
ds_read_b64_tr_b16 v[122:123], v246 offset:49664
buffer_load_dwordx4 v[76:79], v248, s[44:47], s78 offen offset:2304 sc1
v_mfma_f32_16x16x32_bf16 v[28:31], v[92:95], v[36:39], v[28:31]
ds_read_b64_tr_b16 v[124:125], v247 offset:49152
v_mfma_f32_16x16x32_bf16 v[12:15], v[92:95], v[32:35], v[12:15]
ds_read_b64_tr_b16 v[126:127], v247 offset:49664
s_waitcnt vmcnt(8) lgkmcnt(8)
v_mfma_f32_16x16x32_bf16 v[0:3], v[96:99], v[40:43], v[0:3]
v_add_u32 v244, 4294868992, v244
v_add_u32 v245, 4294868992, v245
v_add_u32 v246, 4294868992, v246
v_add_u32 v247, 4294868992, v247
ds_read_b64_tr_b16 v[80:81], v244 offset:0
v_mfma_f32_16x16x32_bf16 v[16:19], v[96:99], v[44:47], v[16:19]
ds_read_b64_tr_b16 v[82:83], v244 offset:512
v_mfma_f32_16x16x32_bf16 v[20:23], v[100:103], v[44:47], v[20:23]
ds_read_b64_tr_b16 v[84:85], v245 offset:0
v_mfma_f32_16x16x32_bf16 v[4:7], v[100:103], v[40:43], v[4:7]
ds_read_b64_tr_b16 v[86:87], v245 offset:512
v_mfma_f32_16x16x32_bf16 v[8:11], v[104:107], v[40:43], v[8:11]
ds_read_b64_tr_b16 v[88:89], v246 offset:0
v_mfma_f32_16x16x32_bf16 v[24:27], v[104:107], v[44:47], v[24:27]
ds_read_b64_tr_b16 v[90:91], v246 offset:512
v_mfma_f32_16x16x32_bf16 v[28:31], v[108:111], v[44:47], v[28:31]
ds_read_b64_tr_b16 v[92:93], v247 offset:0
v_mfma_f32_16x16x32_bf16 v[12:15], v[108:111], v[40:43], v[12:15]
ds_read_b64_tr_b16 v[94:95], v247 offset:512
s_waitcnt vmcnt(6) lgkmcnt(8)
v_mfma_f32_16x16x32_bf16 v[0:3], v[112:115], v[48:51], v[0:3]
ds_read_b64_tr_b16 v[96:97], v244 offset:8192
v_mfma_f32_16x16x32_bf16 v[16:19], v[112:115], v[52:55], v[16:19]
ds_read_b64_tr_b16 v[98:99], v244 offset:8704
v_mfma_f32_16x16x32_bf16 v[20:23], v[116:119], v[52:55], v[20:23]
ds_read_b64_tr_b16 v[100:101], v245 offset:8192
v_mfma_f32_16x16x32_bf16 v[4:7], v[116:119], v[48:51], v[4:7]
ds_read_b64_tr_b16 v[102:103], v245 offset:8704
v_mfma_f32_16x16x32_bf16 v[8:11], v[120:123], v[48:51], v[8:11]
ds_read_b64_tr_b16 v[104:105], v246 offset:8192
v_mfma_f32_16x16x32_bf16 v[24:27], v[120:123], v[52:55], v[24:27]
ds_read_b64_tr_b16 v[106:107], v246 offset:8704
v_mfma_f32_16x16x32_bf16 v[28:31], v[124:127], v[52:55], v[28:31]
ds_read_b64_tr_b16 v[108:109], v247 offset:8192
v_mfma_f32_16x16x32_bf16 v[12:15], v[124:127], v[48:51], v[12:15]
ds_read_b64_tr_b16 v[110:111], v247 offset:8704
s_waitcnt vmcnt(4) lgkmcnt(8)
v_mfma_f32_16x16x32_bf16 v[0:3], v[80:83], v[56:59], v[0:3]
ds_read_b64_tr_b16 v[112:113], v244 offset:16384
v_mfma_f32_16x16x32_bf16 v[16:19], v[80:83], v[60:63], v[16:19]
ds_read_b64_tr_b16 v[114:115], v244 offset:16896
v_mfma_f32_16x16x32_bf16 v[20:23], v[84:87], v[60:63], v[20:23]
ds_read_b64_tr_b16 v[116:117], v245 offset:16384
v_mfma_f32_16x16x32_bf16 v[4:7], v[84:87], v[56:59], v[4:7]
ds_read_b64_tr_b16 v[118:119], v245 offset:16896
v_mfma_f32_16x16x32_bf16 v[8:11], v[88:91], v[56:59], v[8:11]
ds_read_b64_tr_b16 v[120:121], v246 offset:16384
v_mfma_f32_16x16x32_bf16 v[24:27], v[88:91], v[60:63], v[24:27]
ds_read_b64_tr_b16 v[122:123], v246 offset:16896
v_mfma_f32_16x16x32_bf16 v[28:31], v[92:95], v[60:63], v[28:31]
ds_read_b64_tr_b16 v[124:125], v247 offset:16384
v_mfma_f32_16x16x32_bf16 v[12:15], v[92:95], v[56:59], v[12:15]
ds_read_b64_tr_b16 v[126:127], v247 offset:16896
s_waitcnt vmcnt(2) lgkmcnt(8)
v_mfma_f32_16x16x32_bf16 v[0:3], v[96:99], v[64:67], v[0:3]
v_mfma_f32_16x16x32_bf16 v[16:19], v[96:99], v[68:71], v[16:19]
v_xor_b32 v245, 32, v250
v_mfma_f32_16x16x32_bf16 v[20:23], v[100:103], v[68:71], v[20:23]
v_xor_b32 v246, 64, v250
v_mfma_f32_16x16x32_bf16 v[4:7], v[100:103], v[64:67], v[4:7]
v_xor_b32 v247, 96, v250
v_mfma_f32_16x16x32_bf16 v[8:11], v[104:107], v[64:67], v[8:11]
v_mfma_f32_16x16x32_bf16 v[24:27], v[104:107], v[68:71], v[24:27]
v_mfma_f32_16x16x32_bf16 v[28:31], v[108:111], v[68:71], v[28:31]
v_mfma_f32_16x16x32_bf16 v[12:15], v[108:111], v[64:67], v[12:15]
s_waitcnt vmcnt(0) lgkmcnt(0)
v_mfma_f32_16x16x32_bf16 v[0:3], v[112:115], v[72:75], v[0:3]
v_mfma_f32_16x16x32_bf16 v[16:19], v[112:115], v[76:79], v[16:19]
v_mfma_f32_16x16x32_bf16 v[20:23], v[116:119], v[76:79], v[20:23]
v_mfma_f32_16x16x32_bf16 v[4:7], v[116:119], v[72:75], v[4:7]
v_mfma_f32_16x16x32_bf16 v[8:11], v[120:123], v[72:75], v[8:11]
v_mfma_f32_16x16x32_bf16 v[24:27], v[120:123], v[76:79], v[24:27]
v_mfma_f32_16x16x32_bf16 v[28:31], v[124:127], v[76:79], v[28:31]
v_mfma_f32_16x16x32_bf16 v[12:15], v[124:127], v[72:75], v[12:15]
s_nop 0
ds_write_b128 v250, v[0:3] offset:0
ds_write_b128 v250, v[16:19] offset:4096
ds_write_b128 v245, v[20:23] offset:4096
ds_write_b128 v245, v[4:7] offset:0
ds_write_b128 v246, v[8:11] offset:0
ds_write_b128 v246, v[24:27] offset:4096
ds_write_b128 v247, v[28:31] offset:4096
ds_write_b128 v247, v[12:15] offset:0
s_waitcnt lgkmcnt(0)
L_fin:
v_xor_b32 v249, 0x80, v254
s_barrier
ds_read_b128 v[16:19], v254 offset:24576
ds_read_b128 v[24:27], v254 offset:40960
ds_read_b128 v[20:23], v249 offset:24576
ds_read_b128 v[28:31], v249 offset:40960
s_waitcnt lgkmcnt(2)
v_pk_add_f32 v[16:17], v[16:17], v[24:25]
v_pk_add_f32 v[18:19], v[18:19], v[26:27]
s_waitcnt lgkmcnt(0)
v_pk_add_f32 v[20:21], v[20:21], v[28:29]
v_pk_add_f32 v[22:23], v[22:23], v[30:31]
v_cvt_pk_bf16_f32 v16, v16, v17
v_cvt_pk_bf16_f32 v17, v18, v19
v_cvt_pk_bf16_f32 v18, v20, v21
v_cvt_pk_bf16_f32 v19, v22, v23
buffer_store_dwordx4 v[16:19], v255, s[48:51], s42 offen sc1
s_endpgm
L_codeend:
.section .rodata,"a"
.p2align 6
.amdhsa_kernel gated_mix__linear_attn_block__glu_gated_swiglu__prompt_kernel
  .amdhsa_next_free_vgpr 256
  .amdhsa_next_free_sgpr 102
  .amdhsa_accum_offset 256
  .amdhsa_group_segment_fixed_size 0
  .amdhsa_kernarg_size 88
  .amdhsa_user_sgpr_count 2
  .amdhsa_user_sgpr_kernarg_segment_ptr 1
  .amdhsa_system_sgpr_workgroup_id_x 1
.end_amdhsa_kernel
```
